```python
import torch

def _softmax(x, axis=-1):
    return torch.softmax(x, dim=axis)
def _gelu(x):
    return torch.nn.functional.gelu(x, approximate="tanh")
def _silu(x):
    return torch.nn.functional.silu(x)
def _sigmoid(x):
    return torch.sigmoid(x)
def _layernorm(x, axis=-1, eps=1e-5):
    m = x.mean(dim=axis, keepdim=True)
    v = x.var(dim=axis, keepdim=True, unbiased=False)
    return (x - m) / torch.sqrt(v + eps)
def _scatter_add(tgt, idx, src, axis=0):
    return tgt.clone().index_add_(axis, idx, src)
def _segment_sum(src, seg, n):
    out = torch.zeros((n,) + src.shape[1:], dtype=src.dtype)
    return out.index_add_(0, seg, src)
def _pad(x, pw):
    flat = tuple(v for pair in reversed(pw) for v in pair)
    return torch.nn.functional.pad(x, flat)

kernel_name = 'parallel_sum__linear_kernel_hedgehog__dense_activation_gelu__prompt'

def setup_inputs():

    _w = (lambda a: (lambda t: t.to(torch.bfloat16) if t.is_floating_point() else t)(torch.as_tensor(a)))
    def _A_setup():
        B, S, D, H = 1, 2048, 512, 32
        Dh = D // H
        return {
            "x": _w((lambda *s: torch.randn(*s, dtype=torch.bfloat16) * 0.05)(B, S, D)),
            "wqkv": _w((lambda *s: torch.randn(*s, dtype=torch.bfloat16) * 0.2)(D, 3 * D)),
            "w_phi": _w((lambda *s: torch.randn(*s, dtype=torch.bfloat16) * 0.2)(H, Dh, Dh) * (Dh ** -0.5)),
            "wo": _w((lambda *s: torch.randn(*s, dtype=torch.bfloat16) * 0.05)(D, D)),
        }
    _A_in = _A_setup()

    def _B_setup():
        B, S, D, F = 1, 2048, 512, 1792
        return {
            "x": _w((lambda *s: torch.randn(*s, dtype=torch.bfloat16) * 0.05)(B, S, D)),
            "w1": _w((lambda *s: torch.randn(*s, dtype=torch.bfloat16) * 0.8)(D, F) * (D ** -0.5)),
            "b1": _w((lambda *s: torch.randn(*s, dtype=torch.bfloat16) * 12.8)(F) * 0.01),
            "w2": _w((lambda *s: torch.randn(*s, dtype=torch.bfloat16) * 0.4)(F, D) * (F ** -0.5)),
            "b2": _w((lambda *s: torch.randn(*s, dtype=torch.bfloat16) * 6.4)(D) * 0.01),
        }
    _B_in = _B_setup()

    return {
        "A_x": _A_in["x"],
        "A_wqkv": _A_in["wqkv"],
        "A_w_phi": _A_in["w_phi"],
        "A_wo": _A_in["wo"],
        "B_x": _B_in["x"],
        "B_w1": _B_in["w1"],
        "B_b1": _B_in["b1"],
        "B_w2": _B_in["w2"],
        "B_b2": _B_in["b2"],
    }

def reference(A_x, A_wqkv, A_w_phi, A_wo, B_x, B_w1, B_b1, B_w2, B_b2):
    def _A_ref(x, wqkv, w_phi, wo):
        B, S, D = x.shape
        H = 32; Dh = D // H
        qkv = (lambda x, *d: x.permute(*d))((x @ wqkv).reshape(B, S, 3, H, Dh), 2, 0, 3, 1, 4)
        q, k, v = qkv[0], qkv[1], qkv[2]
        pq = torch.einsum("bhsd,hdf->bhsf", q, w_phi)
        pk = torch.einsum("bhsd,hdf->bhsf", k, w_phi)
        phi_q = torch.concatenate([_softmax(pq, axis=-1), _softmax(-pq, axis=-1)], axis=-1)
        phi_k = torch.concatenate([_softmax(pk, axis=-1), _softmax(-pk, axis=-1)], axis=-1)
        kv = torch.einsum("bhsf,bhsd->bhfd", phi_k, v)
        z  = torch.einsum("bhsf->bhf", phi_k)
        num = torch.einsum("bhqf,bhfd->bhqd", phi_q, kv)
        den = torch.einsum("bhqf,bhf->bhq", phi_q, z)[..., None] + 1e-6
        o = num / den
        return (lambda x, *d: x.permute(*d))(o, 0, 2, 1, 3).reshape(B, S, D) @ wo

    def _B_ref(x, w1, b1, w2, b2):
        h = torch.einsum("bsd,df->bsf", x, w1) + b1
        h = _gelu(h)
        return torch.einsum("bsf,fd->bsd", h, w2) + b2

    x = A_x
    xn = _layernorm(x, axis=-1)
    return x + _A_ref(xn, A_wqkv, A_w_phi, A_wo) + _B_ref(xn, B_w1, B_b1, B_w2, B_b2)
```

```asm
; @launch grid=(256,1,1) block=(512,1,1) lds=163840
.amdgcn_target "amdgcn-amd-amdhsa--gfx950"
.text
.globl parallel_sum__linear_kernel_hedgehog__dense_activation_gelu__prompt_kernel
.p2align 8
.type parallel_sum__linear_kernel_hedgehog__dense_activation_gelu__prompt_kernel,@function
parallel_sum__linear_kernel_hedgehog__dense_activation_gelu__prompt_kernel:
    s_cmp_ge_u32 s2, 256
    s_cbranch_scc1 K_END
    s_load_dwordx4 s[64:67], s[0:1], 0
    s_load_dwordx2 s[68:69], s[0:1], 16
    s_load_dwordx4 s[72:75], s[0:1], 40
    s_load_dwordx2 s[70:71], s[0:1], 88
    s_load_dwordx2 s[96:97], s[0:1], 56
    s_load_dwordx2 s[98:99], s[0:1], 24
    s_load_dwordx2 s[4:5], s[0:1], 80
    v_lshrrev_b32 v8, 6, v0
    v_and_b32 v1, 63, v0
    v_readfirstlane_b32 s24, v8
    s_lshr_b32 s32, s2, 3
    s_cmp_lg_u32 s24, 7
    s_cbranch_scc1 K_NOPF
    s_getpc_b64 s[62:63]
    s_and_b32 s62, s62, 0xffffff00
    s_mul_i32 s39, s32, 1024
    v_lshl_add_u32 v11, v1, 7, s39
    s_mov_b64 exec, 0xff
    global_load_dword v0, v11, s[62:63]
    s_mov_b64 exec, -1
K_NOPF:
    s_and_b32 s38, s2, 7
    s_lshr_b32 s28, s38, 1
    s_lshl_b32 s28, s28, 2
    s_and_b32 s40, s32, 3
    s_add_u32 s28, s28, s40
    s_lshr_b32 s39, s32, 2
    s_add_u32 s33, s39, s40
    s_and_b32 s33, s33, 3
    s_and_b32 s29, s39, 1
    s_lshr_b32 s39, s39, 1
    s_and_b32 s27, s38, 1
    s_lshl_b32 s27, s27, 2
    s_add_u32 s27, s27, s39
    s_and_b32 s25, s24, 3
    s_lshr_b32 s26, s24, 2
    v_lshrrev_b32 v8, 4, v1
    v_and_b32 v9, 15, v1
    v_xor_b32 v10, v8, v9
    v_lshlrev_b32 v10, 4, v10
    v_lshl_add_u32 v40, v8, 10, v10
    v_xor_b32 v41, 4160, v40
    v_xor_b32 v42, 8320, v40
    v_xor_b32 v43, 12480, v40
    s_lshl_b32 s43, s28, 17
    s_lshl_b32 s38, s24, 14
    s_add_u32 s43, s43, s38
    s_lshl_b32 s57, s24, 12
    v_and_b32 v11, 31, v1
    v_lshrrev_b32 v12, 5, v1
    s_cmp_eq_u32 s29, 0
    s_cbranch_scc1 K_SETQ
    s_movk_i32 s30, 3584
    s_mul_i32 s51, s27, 448
    s_and_b32 s39, s27, 1
    s_lshl_b32 s40, s39, 6
    s_add_u32 s44, s51, s40
    s_add_u32 s45, s44, 128
    s_add_u32 s46, s44, 256
    s_lshl_b32 s40, s39, 9
    s_add_u32 s47, s44, 384
    s_sub_u32 s47, s47, s40
    s_lshl_b32 s40, s26, 6
    v_lshl_add_u32 v50, v11, 1, s40
    s_mov_b32 s14, 1835008
    s_movk_i32 s22, 3584
    s_branch K_SETD
K_SETQ:
    s_movk_i32 s30, 3072
    s_lshl_b32 s46, s27, 7
    s_add_u32 s44, s46, 1024
    s_add_u32 s45, s46, 2048
    s_lshl_b32 s39, s26, 10
    s_lshl_b32 s51, s27, 11
    s_add_u32 s39, s39, s51
    v_lshl_add_u32 v50, v1, 4, s39
    s_mov_b32 s14, 1572864
    s_movk_i32 s22, 16384
K_SETD:
    s_mov_b32 s15, 0x00020000
    s_mov_b32 s23, 0x00020000
    v_lshrrev_b32 v3, 2, v1
    v_mul_lo_u32 v3, v3, s30
    v_and_b32 v13, 3, v1
    v_lshl_add_u32 v3, v13, 4, v3
    s_lshl_b32 s52, s30, 4
    s_mul_i32 s100, s52, s24
    s_add_u32 s100, s100, s44
    s_cmp_eq_u32 s29, 0
    s_waitcnt lgkmcnt(0)
    s_cselect_b64 s[12:13], s[66:67], s[72:73]
    s_cselect_b64 s[20:21], s[68:69], s[74:75]
    s_mov_b32 s8, s64
    s_mov_b32 s9, s65
    s_mov_b32 s10, 0x200000
    s_mov_b32 s11, 0x00020000
    s_add_u32 s38, s33, 0
    s_and_b32 s38, s38, 3
    s_lshl_b32 s39, s38, 8
    s_add_u32 s39, s39, s43
    s_lshl_b32 s38, s38, 3
    s_mul_i32 s38, s38, s52
    s_add_u32 s38, s38, s100
    s_add_u32 s40, s38, 64
    s_lshr_b32 s41, s57, 2
    s_add_u32 m0, s57, 131072
    s_nop 0
    buffer_load_dwordx4 v40, s[8:11], s39 offen lds
    s_add_u32 m0, s57, 132096
    s_nop 0
    buffer_load_dwordx4 v41, s[8:11], s39 offen lds
    s_add_u32 m0, s57, 133120
    s_nop 0
    buffer_load_dwordx4 v42, s[8:11], s39 offen lds
    s_add_u32 m0, s57, 134144
    s_nop 0
    buffer_load_dwordx4 v43, s[8:11], s39 offen lds
    s_add_u32 m0, s41, 0
    s_nop 0
    buffer_load_dwordx4 v3, s[12:15], s38 offen lds
    s_add_u32 m0, s41, 16384
    s_nop 0
    buffer_load_dwordx4 v3, s[12:15], s40 offen lds
    s_mov_b32 s16, s70
    s_mov_b32 s17, s71
    s_mov_b32 s18, 0x10000000
    s_mov_b32 s19, 0x00020000
    s_movk_i32 s6, 256
    s_mov_b32 s7, 0x00020000
    s_lshl_b32 s31, s28, 2
    s_add_u32 s31, s31, s25
    s_lshl_b32 s60, s29, 4
    s_add_u32 s60, s60, s28
    s_lshl_b32 s60, s60, 3
    s_add_u32 s60, s60, s27
    s_lshl_b32 s60, s60, 10
    s_add_u32 s60, s60, 23134208
    s_and_b32 s77, s27, 1
    s_xor_b32 s77, s77, s26
    v_lshlrev_b32 v2, 4, v1
    v_mov_b32 v28, 0
    v_mov_b32 v29, 0
    s_lshl_b32 s49, s29, 3
    s_add_u32 s49, s49, s24
    s_cmp_lg_u32 s49, 15
    s_cbranch_scc1 K_NZ
    v_lshlrev_b32 v10, 3, v1
    buffer_store_dwordx2 v[28:29], v10, s[16:19], s60 offen sc1
    buffer_store_dwordx2 v[28:29], v10, s[16:19], s60 offen offset:512 sc1
K_NZ:
    s_lshl_b32 s38, s24, 7
    s_add_u32 s60, s60, s38
    s_lshl_b32 s38, s33, 2
    s_add_u32 s38, s38, s24
    s_and_b32 s39, s38, 15
    s_lshl_b32 s39, s39, 1
    s_mul_i32 s56, s39, s52
    s_add_u32 s38, s38, 8
    s_and_b32 s39, s38, 15
    s_lshl_b32 s39, s39, 1
    s_mul_i32 s76, s39, s52
    s_sub_u32 s76, s76, s56
    s_sub_u32 s76, s76, s52
    s_lshl_b32 s42, s24, 11
    s_lshr_b32 s38, s31, 1
    s_and_b32 s38, s38, 6
    s_and_b32 s62, s31, 1
    s_or_b32 s38, s38, s62
    s_cmp_eq_u32 s38, 3
    s_cselect_b32 s38, 7, s38
    s_lshl_b32 s38, s38, 7
    s_add_u32 s38, s38, 640
    s_mov_b32 s62, 0xff000000
    s_mov_b32 s63, 0
    v_mov_b32 v127, s38
    v_cndmask_b32 v127, 0, v127, s[62:63]
    v_add_u32 v127, v127, v2
    s_and_b32 s38, s31, 1
    s_lshl_b32 s38, s38, 10
    v_xor_b32 v127, s38, v127
    s_mov_b32 s34, 0x3f803f80
    s_mov_b32 s35, 0x00003f80
    s_mov_b32 s36, 0x3f800000
    s_mov_b32 s37, 0xffff0000
    v_lshlrev_b32 v10, 9, v12
    v_bfe_u32 v8, v1, 2, 2
    v_lshl_add_u32 v10, v8, 6, v10
    v_bfe_u32 v14, v1, 4, 1
    v_lshl_add_u32 v10, v14, 5, v10
    v_lshl_add_u32 v10, v13, 3, v10
    s_xor_b32 s41, s25, s26
    s_lshl_b32 s39, s26, 14
    s_xor_b32 s38, s41, 0
    s_lshl_b32 s38, s38, 10
    s_add_u32 s38, s38, s39
    v_add_u32 v4, s38, v10
    s_xor_b32 s38, s41, 1
    s_lshl_b32 s38, s38, 10
    s_add_u32 s38, s38, s39
    v_add_u32 v5, s38, v10
    s_xor_b32 s38, s41, 2
    s_lshl_b32 s38, s38, 10
    s_add_u32 s38, s38, s39
    v_add_u32 v6, s38, v10
    s_xor_b32 s38, s41, 3
    s_lshl_b32 s38, s38, 10
    s_add_u32 s38, s38, s39
    v_add_u32 v7, s38, v10
    v_and_b32 v8, 1, v8
    v_cmp_eq_u32 vcc, v8, v14
    v_mov_b32 v8, s34
    v_cmp_gt_u32 s[58:59], 16, v11
    v_cndmask_b32 v16, 0, v8, vcc
    v_cndmask_b32 v17, 0, v8, vcc
    v_cndmask_b32 v18, 0, v8, vcc
    v_cndmask_b32 v19, 0, v8, vcc
    v_xor_b32 v8, v12, v9
    v_lshlrev_b32 v8, 4, v8
    v_lshl_add_u32 v8, v11, 8, v8
    s_lshl_b32 s38, s41, 5
    v_xor_b32 v8, s38, v8
    s_lshl_b32 s38, s25, 13
    s_add_u32 s38, s38, 98304
    v_add_u32 v32, s38, v8
    v_xor_b32 v33, 32, v32
    v_xor_b32 v34, 64, v32
    v_xor_b32 v35, 96, v32
    v_xor_b32 v36, 128, v32
    v_xor_b32 v37, 160, v32
    v_xor_b32 v38, 192, v32
    v_xor_b32 v39, 224, v32
    s_lshl_b32 s38, s26, 9
    s_add_u32 s38, s38, 133120
    v_lshl_add_u32 v15, v11, 4, s38
    s_lshl_b32 s38, s25, 2
    v_add_u32 v14, s38, v15
    v_mov_b32 v48, 0
    v_mov_b32 v49, 0
    v_lshrrev_b32 v126, 3, v1
    v_lshlrev_b32 v126, 10, v126
    v_and_b32 v10, 7, v1
    v_bfe_u32 v11, v1, 4, 1
    v_lshlrev_b32 v11, 2, v11
    v_xor_b32 v11, v10, v11
    v_lshl_add_u32 v126, v11, 4, v126
    v_lshrrev_b32 v10, 1, v1
    v_lshlrev_b32 v10, 9, v10
    v_and_b32 v11, 1, v1
    v_lshl_add_u32 v10, v11, 7, v10
    v_mov_b32 v52, -1
    v_mov_b32 v53, -1
    v_mov_b32 v54, -1
    v_mov_b32 v55, -1
    s_cmp_lg_u32 s29, 0
    s_cbranch_scc1 K_NSEL
    v_lshlrev_b32 v12, 2, v12
    v_sub_u32 v12, v9, v12
    v_mov_b32 v8, s35
    v_mov_b32 v13, s36
    v_cmp_eq_u32 vcc, 0, v12
    v_cmp_eq_u32 s[62:63], 1, v12
    s_nop 0
    v_cndmask_b32 v124, 0, v8, vcc
    v_cndmask_b32 v124, v124, v13, s[62:63]
    v_cmp_eq_u32 vcc, 2, v12
    v_cmp_eq_u32 s[62:63], 3, v12
    s_nop 0
    v_cndmask_b32 v125, 0, v8, vcc
    v_cndmask_b32 v125, v125, v13, s[62:63]
    v_cmp_eq_u32 vcc, 8, v12
    v_cmp_eq_u32 s[62:63], 9, v12
    s_nop 0
    v_cndmask_b32 v126, 0, v8, vcc
    v_cndmask_b32 v126, v126, v13, s[62:63]
    v_cmp_eq_u32 vcc, 10, v12
    v_cmp_eq_u32 s[62:63], 11, v12
    s_nop 0
    v_cndmask_b32 v127, 0, v8, vcc
    v_cndmask_b32 v127, v127, v13, s[62:63]
    v_cndmask_b32 v120, 0, v124, s[58:59]
    v_cndmask_b32 v124, v124, 0, s[58:59]
    v_cndmask_b32 v121, 0, v125, s[58:59]
    v_cndmask_b32 v125, v125, 0, s[58:59]
    v_cndmask_b32 v122, 0, v126, s[58:59]
    v_cndmask_b32 v126, v126, 0, s[58:59]
    v_cndmask_b32 v123, 0, v127, s[58:59]
    v_cndmask_b32 v127, v127, 0, s[58:59]
    v_bfe_u32 v8, v1, 4, 1
    v_lshlrev_b32 v116, 9, v8
    v_lshrrev_b32 v8, 5, v1
    v_lshl_add_u32 v116, v8, 7, v116
    v_lshl_add_u32 v116, v9, 3, v116
    s_lshl_b32 s38, s24, 10
    v_add_u32 v116, s38, v116
K_NSEL:
    s_mul_i32 s50, s31, 229376
    s_lshl_b32 s38, s26, 12
    s_add_u32 s50, s50, s38
    s_and_b32 s51, s27, 1
    s_lshl_b32 s51, s51, 6
    s_add_u32 s51, s51, s47
    s_lshl_b32 s48, s51, 6
    s_add_u32 s48, s48, s50
    s_lshl_b32 s38, s26, 11
    s_sub_u32 s48, s48, s38
    s_cmp_ge_u32 s27, 4
    s_cbranch_scc1 K_NQ3
    s_mov_b64 s[92:93], s[66:67]
    s_mov_b32 s94, 1572864
    s_mov_b32 s95, 0x00020000
    s_lshl_b32 s38, s32, 3
    s_add_u32 s38, s38, s24
    s_mul_i32 s38, s38, 6144
    s_buffer_load_dword s3, s[92:95], s38 offset:2432
    s_buffer_load_dword s3, s[92:95], s38 offset:2496
    s_buffer_load_dword s3, s[92:95], s38 offset:5504
    s_buffer_load_dword s3, s[92:95], s38 offset:5568
    s_buffer_load_dword s3, s[92:95], s38 offset:384
    s_buffer_load_dword s3, s[92:95], s38 offset:448
    s_buffer_load_dword s3, s[92:95], s38 offset:3456
    s_buffer_load_dword s3, s[92:95], s38 offset:3520
K_NQ3:
    s_add_u32 s38, s33, 1
    s_and_b32 s38, s38, 3
    s_lshl_b32 s39, s38, 8
    s_add_u32 s39, s39, s43
    s_lshl_b32 s38, s38, 3
    s_mul_i32 s38, s38, s52
    s_add_u32 s38, s38, s100
    s_add_u32 s40, s38, 64
    s_lshr_b32 s41, s57, 2
    s_add_u32 m0, s57, 65536
    s_nop 0
    buffer_load_dwordx4 v40, s[8:11], s39 offen lds
    s_add_u32 m0, s57, 66560
    s_nop 0
    buffer_load_dwordx4 v41, s[8:11], s39 offen lds
    s_add_u32 m0, s57, 67584
    s_nop 0
    buffer_load_dwordx4 v42, s[8:11], s39 offen lds
    s_add_u32 m0, s57, 68608
    s_nop 0
    buffer_load_dwordx4 v43, s[8:11], s39 offen lds
    s_add_u32 m0, s41, 8192
    s_nop 0
    buffer_load_dwordx4 v3, s[12:15], s38 offen lds
    s_add_u32 m0, s41, 24576
    s_nop 0
    buffer_load_dwordx4 v3, s[12:15], s40 offen lds
    s_waitcnt vmcnt(6) lgkmcnt(0)
    s_barrier
    ds_read_b128 v[128:131], v32 offset:32768
    ds_read_b64_tr_b16 v[96:97], v4 offset:0
    ds_read_b64_tr_b16 v[98:99], v4 offset:256
    ds_read_b128 v[132:135], v33 offset:32768
    ds_read_b64_tr_b16 v[100:101], v5 offset:0
    ds_read_b64_tr_b16 v[102:103], v5 offset:256
    ds_read_b128 v[136:139], v34 offset:32768
    ds_read_b64_tr_b16 v[104:105], v6 offset:0
    ds_read_b64_tr_b16 v[106:107], v6 offset:256
    ds_read_b128 v[140:143], v35 offset:32768
    ds_read_b64_tr_b16 v[108:109], v7 offset:0
    ds_read_b64_tr_b16 v[110:111], v7 offset:256
    s_add_u32 s38, s33, 2
    s_and_b32 s38, s38, 3
    s_lshl_b32 s39, s38, 8
    s_add_u32 s39, s39, s43
    s_lshl_b32 s38, s38, 3
    s_mul_i32 s38, s38, s52
    s_add_u32 s38, s38, s100
    s_add_u32 s40, s38, 64
    s_lshr_b32 s41, s57, 2
    s_add_u32 m0, s57, 98304
    s_nop 0
    buffer_load_dwordx4 v40, s[8:11], s39 offen lds
    ds_read_b128 v[144:147], v36 offset:32768
    ds_read_b64_tr_b16 v[112:113], v4 offset:4096
    ds_read_b64_tr_b16 v[114:115], v4 offset:4352
    s_waitcnt lgkmcnt(12)
    v_mfma_f32_32x32x16_bf16 v[64:79], v[96:99], v[128:131], 0
    v_mfma_f32_16x16x32_bf16 v[20:23], v[16:19], v[96:99], 0
    v_mfma_f32_16x16x32_bf16 v[44:47], v[16:19], v[128:131], 0
    v_dot2c_f32_bf16 v48, v128, v128
    v_dot2c_f32_bf16 v49, v129, v129
    v_dot2c_f32_bf16 v48, v130, v130
    v_dot2c_f32_bf16 v49, v131, v131
    s_add_u32 m0, s57, 99328
    s_nop 0
    buffer_load_dwordx4 v41, s[8:11], s39 offen lds
    ds_read_b128 v[148:151], v37 offset:32768
    ds_read_b64_tr_b16 v[96:97], v5 offset:4096
    ds_read_b64_tr_b16 v[98:99], v5 offset:4352
    s_waitcnt lgkmcnt(12)
    v_mfma_f32_32x32x16_bf16 v[64:79], v[100:103], v[132:135], v[64:79]
    s_add_u32 m0, s57, 100352
    s_nop 0
    buffer_load_dwordx4 v42, s[8:11], s39 offen lds
    ds_read_b128 v[152:155], v38 offset:32768
    ds_read_b64_tr_b16 v[100:101], v6 offset:4096
    ds_read_b64_tr_b16 v[102:103], v6 offset:4352
    s_waitcnt lgkmcnt(12)
    v_mfma_f32_32x32x16_bf16 v[64:79], v[104:107], v[136:139], v[64:79]
    v_mfma_f32_16x16x32_bf16 v[44:47], v[16:19], v[136:139], v[44:47]
    v_dot2c_f32_bf16 v48, v136, v136
    v_dot2c_f32_bf16 v49, v137, v137
    v_dot2c_f32_bf16 v48, v138, v138
    v_dot2c_f32_bf16 v49, v139, v139
    s_add_u32 m0, s57, 101376
    s_nop 0
    buffer_load_dwordx4 v43, s[8:11], s39 offen lds
    ds_read_b128 v[156:159], v39 offset:32768
    ds_read_b64_tr_b16 v[104:105], v7 offset:4096
    ds_read_b64_tr_b16 v[106:107], v7 offset:4352
    s_waitcnt lgkmcnt(12)
    v_mfma_f32_32x32x16_bf16 v[64:79], v[108:111], v[140:143], v[64:79]
    s_add_u32 m0, s41, 32768
    s_nop 0
    buffer_load_dwordx4 v3, s[12:15], s38 offen lds
    s_waitcnt vmcnt(5) lgkmcnt(0)
    s_barrier
    v_subrev_u32 v32, 0x8000, v32
    v_subrev_u32 v33, 0x8000, v33
    v_subrev_u32 v34, 0x8000, v34
    v_subrev_u32 v35, 0x8000, v35
    v_subrev_u32 v36, 0x8000, v36
    v_subrev_u32 v37, 0x8000, v37
    v_subrev_u32 v38, 0x8000, v38
    v_subrev_u32 v39, 0x8000, v39
    ds_read_b128 v[160:163], v32 offset:0
    ds_read_b64_tr_b16 v[108:109], v4 offset:8192
    ds_read_b64_tr_b16 v[110:111], v4 offset:8448
    v_mfma_f32_32x32x16_bf16 v[64:79], v[112:115], v[144:147], v[64:79]
    v_mfma_f32_16x16x32_bf16 v[20:23], v[16:19], v[112:115], v[20:23]
    v_mfma_f32_16x16x32_bf16 v[44:47], v[16:19], v[144:147], v[44:47]
    v_dot2c_f32_bf16 v48, v144, v144
    v_dot2c_f32_bf16 v49, v145, v145
    v_dot2c_f32_bf16 v48, v146, v146
    v_dot2c_f32_bf16 v49, v147, v147
    s_add_u32 m0, s41, 49152
    s_nop 0
    buffer_load_dwordx4 v3, s[12:15], s40 offen lds
    ds_read_b128 v[164:167], v33 offset:0
    ds_read_b64_tr_b16 v[112:113], v5 offset:8192
    ds_read_b64_tr_b16 v[114:115], v5 offset:8448
    v_mfma_f32_32x32x16_bf16 v[64:79], v[96:99], v[148:151], v[64:79]
    ds_read_b128 v[168:171], v34 offset:0
    ds_read_b64_tr_b16 v[96:97], v6 offset:8192
    ds_read_b64_tr_b16 v[98:99], v6 offset:8448
    v_mfma_f32_32x32x16_bf16 v[64:79], v[100:103], v[152:155], v[64:79]
    v_mfma_f32_16x16x32_bf16 v[44:47], v[16:19], v[152:155], v[44:47]
    v_dot2c_f32_bf16 v48, v152, v152
    v_dot2c_f32_bf16 v49, v153, v153
    v_dot2c_f32_bf16 v48, v154, v154
    v_dot2c_f32_bf16 v49, v155, v155
    s_add_u32 s38, s33, 3
    s_and_b32 s38, s38, 3
    s_lshl_b32 s39, s38, 8
    s_add_u32 s39, s39, s43
    s_lshl_b32 s38, s38, 3
    s_mul_i32 s38, s38, s52
    s_add_u32 s38, s38, s100
    s_add_u32 s40, s38, 64
    s_lshr_b32 s41, s57, 2
    s_add_u32 m0, s57, 131072
    s_nop 0
    buffer_load_dwordx4 v40, s[8:11], s39 offen lds
    ds_read_b128 v[172:175], v35 offset:0
    ds_read_b64_tr_b16 v[100:101], v7 offset:8192
    ds_read_b64_tr_b16 v[102:103], v7 offset:8448
    v_mfma_f32_32x32x16_bf16 v[64:79], v[104:107], v[156:159], v[64:79]
    s_add_u32 m0, s57, 132096
    s_nop 0
    buffer_load_dwordx4 v41, s[8:11], s39 offen lds
    ds_read_b128 v[176:179], v36 offset:0
    ds_read_b64_tr_b16 v[104:105], v4 offset:12288
    ds_read_b64_tr_b16 v[106:107], v4 offset:12544
    s_waitcnt lgkmcnt(12)
    v_mfma_f32_32x32x16_bf16 v[64:79], v[108:111], v[160:163], v[64:79]
    v_mfma_f32_16x16x32_bf16 v[20:23], v[16:19], v[108:111], v[20:23]
    v_mfma_f32_16x16x32_bf16 v[44:47], v[16:19], v[160:163], v[44:47]
    v_dot2c_f32_bf16 v48, v160, v160
    v_dot2c_f32_bf16 v49, v161, v161
    v_dot2c_f32_bf16 v48, v162, v162
    v_dot2c_f32_bf16 v49, v163, v163
    s_add_u32 m0, s57, 133120
    s_nop 0
    buffer_load_dwordx4 v42, s[8:11], s39 offen lds
    ds_read_b128 v[180:183], v37 offset:0
    ds_read_b64_tr_b16 v[108:109], v5 offset:12288
    ds_read_b64_tr_b16 v[110:111], v5 offset:12544
    s_waitcnt lgkmcnt(12)
    v_mfma_f32_32x32x16_bf16 v[64:79], v[112:115], v[164:167], v[64:79]
    s_add_u32 m0, s57, 134144
    s_nop 0
    buffer_load_dwordx4 v43, s[8:11], s39 offen lds
    ds_read_b128 v[184:187], v38 offset:0
    ds_read_b64_tr_b16 v[112:113], v6 offset:12288
    ds_read_b64_tr_b16 v[114:115], v6 offset:12544
    s_waitcnt lgkmcnt(12)
    v_mfma_f32_32x32x16_bf16 v[64:79], v[96:99], v[168:171], v[64:79]
    v_mfma_f32_16x16x32_bf16 v[44:47], v[16:19], v[168:171], v[44:47]
    v_dot2c_f32_bf16 v48, v168, v168
    v_dot2c_f32_bf16 v49, v169, v169
    v_dot2c_f32_bf16 v48, v170, v170
    v_dot2c_f32_bf16 v49, v171, v171
    s_add_u32 m0, s41, 40960
    s_nop 0
    buffer_load_dwordx4 v3, s[12:15], s38 offen lds
    ds_read_b128 v[188:191], v39 offset:0
    ds_read_b64_tr_b16 v[96:97], v7 offset:12288
    ds_read_b64_tr_b16 v[98:99], v7 offset:12544
    s_waitcnt lgkmcnt(12)
    v_mfma_f32_32x32x16_bf16 v[64:79], v[100:103], v[172:175], v[64:79]
    s_add_u32 m0, s41, 57344
    s_nop 0
    buffer_load_dwordx4 v3, s[12:15], s40 offen lds
    s_lshr_b32 s38, s24, 1
    s_cmp_lg_u32 s38, 2
    s_cbranch_scc1 K_NW
    s_cmp_eq_u32 s24, 4
    s_cselect_b64 s[92:93], s[72:73], s[66:67]
    s_mov_b32 s38, 1835008
    s_cselect_b32 s94, s38, 1572864
    s_mov_b32 s95, 0x00020000
    s_movk_i32 s38, 7168
    s_cselect_b32 s38, s38, 6144
    s_cselect_b32 s39, 56, 48
    s_mul_i32 s38, s38, s2
    v_lshlrev_b32 v0, 7, v1
    s_bfm_b64 exec, s39, 0
    buffer_load_dword v0, v0, s[92:95], s38 offen
    s_mov_b64 exec, -1
K_NW:
    s_add_u32 s53, s56, s45
    s_add_u32 s55, s42, 65536
    s_waitcnt vmcnt(6) lgkmcnt(0)
    s_barrier
    ds_read_b128 v[192:195], v32 offset:32768
    ds_read_b64_tr_b16 v[100:101], v4 offset:32768
    ds_read_b64_tr_b16 v[102:103], v4 offset:33024
    v_mfma_f32_32x32x16_bf16 v[64:79], v[104:107], v[176:179], v[64:79]
    v_mfma_f32_16x16x32_bf16 v[20:23], v[16:19], v[104:107], v[20:23]
    v_mfma_f32_16x16x32_bf16 v[44:47], v[16:19], v[176:179], v[44:47]
    v_dot2c_f32_bf16 v48, v176, v176
    v_dot2c_f32_bf16 v49, v177, v177
    v_dot2c_f32_bf16 v48, v178, v178
    v_dot2c_f32_bf16 v49, v179, v179
    s_mov_b32 m0, s55
    s_add_u32 s54, s53, 64
    buffer_load_dwordx4 v3, s[12:15], s53 offen lds
    ds_read_b128 v[196:199], v33 offset:32768
    ds_read_b64_tr_b16 v[104:105], v5 offset:32768
    ds_read_b64_tr_b16 v[106:107], v5 offset:33024
    v_mfma_f32_32x32x16_bf16 v[64:79], v[108:111], v[180:183], v[64:79]
    s_add_u32 m0, s55, 0x4000
    s_add_u32 s53, s53, s52
    buffer_load_dwordx4 v3, s[12:15], s54 offen lds
    s_add_u32 s55, s55, 1024
    ds_read_b128 v[200:203], v34 offset:32768
    ds_read_b64_tr_b16 v[108:109], v6 offset:32768
    ds_read_b64_tr_b16 v[110:111], v6 offset:33024
    v_mfma_f32_32x32x16_bf16 v[64:79], v[112:115], v[184:187], v[64:79]
    v_mfma_f32_16x16x32_bf16 v[44:47], v[16:19], v[184:187], v[44:47]
    v_dot2c_f32_bf16 v48, v184, v184
    v_dot2c_f32_bf16 v49, v185, v185
    v_dot2c_f32_bf16 v48, v186, v186
    v_dot2c_f32_bf16 v49, v187, v187
    s_mov_b32 m0, s55
    s_add_u32 s54, s53, 64
    buffer_load_dwordx4 v3, s[12:15], s53 offen lds
    ds_read_b128 v[204:207], v35 offset:32768
    ds_read_b64_tr_b16 v[112:113], v7 offset:32768
    ds_read_b64_tr_b16 v[114:115], v7 offset:33024
    v_mfma_f32_32x32x16_bf16 v[64:79], v[96:99], v[188:191], v[64:79]
    s_add_u32 m0, s55, 0x4000
    s_add_u32 s53, s53, s76
    buffer_load_dwordx4 v3, s[12:15], s54 offen lds
    s_add_u32 s55, s55, 0x7c00
    ds_read_b128 v[208:211], v36 offset:32768
    ds_read_b64_tr_b16 v[96:97], v4 offset:36864
    ds_read_b64_tr_b16 v[98:99], v4 offset:37120
    s_waitcnt lgkmcnt(12)
    v_mfma_f32_32x32x16_bf16 v[64:79], v[100:103], v[192:195], v[64:79]
    v_mfma_f32_16x16x32_bf16 v[20:23], v[16:19], v[100:103], v[20:23]
    v_mfma_f32_16x16x32_bf16 v[44:47], v[16:19], v[192:195], v[44:47]
    v_dot2c_f32_bf16 v48, v192, v192
    v_dot2c_f32_bf16 v49, v193, v193
    v_dot2c_f32_bf16 v48, v194, v194
    v_dot2c_f32_bf16 v49, v195, v195
    ds_read_b128 v[212:215], v37 offset:32768
    ds_read_b64_tr_b16 v[100:101], v5 offset:36864
    ds_read_b64_tr_b16 v[102:103], v5 offset:37120
    s_waitcnt lgkmcnt(12)
    v_mfma_f32_32x32x16_bf16 v[64:79], v[104:107], v[196:199], v[64:79]
    s_lshr_b32 s39, s27, 2
    s_lshl_b32 s40, s28, 1
    s_add_u32 s40, s40, s39
    s_mul_i32 s30, s40, 458752
    s_mul_i32 s38, s25, 57344
    s_add_u32 s30, s30, s38
    s_add_u32 s33, s30, 229376
    s_lshl_b32 s57, s31, 11
    s_lshl_b32 s38, s39, 8
    s_add_u32 s57, s57, s38
    s_add_u32 s57, s57, 23265280
    s_cmp_lg_u32 s77, 0
    s_cselect_b32 s100, 1, 64
    s_lshr_b32 s39, s32, 2
    s_lshl_b32 s39, s39, 7
    s_mul_i32 s43, s25, 458752
    s_add_u32 s43, s43, s39
    s_lshl_b32 s34, s25, 11
    s_lshl_b32 s38, s26, 10
    s_add_u32 s68, s34, s38
    s_lshl_b32 s38, s26, 13
    s_add_u32 s69, s43, s38
    s_mov_b32 s64, s96
    s_mov_b32 s65, s97
    s_mov_b32 s66, 0x1c0000
    s_mov_b32 s67, 0x00020000
    s_lshl_b32 s38, s24, 7
    s_add_u32 s61, s38, 135168
    ds_read_b128 v[216:219], v38 offset:32768
    ds_read_b64_tr_b16 v[104:105], v6 offset:36864
    ds_read_b64_tr_b16 v[106:107], v6 offset:37120
    s_waitcnt lgkmcnt(12)
    v_mfma_f32_32x32x16_bf16 v[64:79], v[108:111], v[200:203], v[64:79]
    v_mfma_f32_16x16x32_bf16 v[44:47], v[16:19], v[200:203], v[44:47]
    v_dot2c_f32_bf16 v48, v200, v200
    v_dot2c_f32_bf16 v49, v201, v201
    v_dot2c_f32_bf16 v48, v202, v202
    v_dot2c_f32_bf16 v49, v203, v203
    ds_read_b128 v[220:223], v39 offset:32768
    ds_read_b64_tr_b16 v[108:109], v7 offset:36864
    ds_read_b64_tr_b16 v[110:111], v7 offset:37120
    s_waitcnt lgkmcnt(12)
    v_mfma_f32_32x32x16_bf16 v[64:79], v[112:115], v[204:207], v[64:79]
    s_waitcnt vmcnt(5) lgkmcnt(0)
    s_lshr_b32 s38, s24, 1
    s_cmp_eq_u32 s38, 2
    s_cbranch_scc1 K_S3
    s_waitcnt vmcnt(4)
K_S3:
    s_barrier
    v_add_u32 v32, 0x8000, v32
    v_add_u32 v33, 0x8000, v33
    v_add_u32 v34, 0x8000, v34
    v_add_u32 v35, 0x8000, v35
    v_add_u32 v36, 0x8000, v36
    v_add_u32 v37, 0x8000, v37
    v_add_u32 v38, 0x8000, v38
    v_add_u32 v39, 0x8000, v39
    ds_read_b128 v[224:227], v32 offset:32768
    ds_read_b64_tr_b16 v[112:113], v4 offset:40960
    ds_read_b64_tr_b16 v[114:115], v4 offset:41216
    v_mfma_f32_32x32x16_bf16 v[64:79], v[96:99], v[208:211], v[64:79]
    v_mfma_f32_16x16x32_bf16 v[20:23], v[16:19], v[96:99], v[20:23]
    v_mfma_f32_16x16x32_bf16 v[44:47], v[16:19], v[208:211], v[44:47]
    v_dot2c_f32_bf16 v48, v208, v208
    v_dot2c_f32_bf16 v49, v209, v209
    v_dot2c_f32_bf16 v48, v210, v210
    v_dot2c_f32_bf16 v49, v211, v211
    s_mov_b32 m0, s55
    s_add_u32 s54, s53, 64
    buffer_load_dwordx4 v3, s[12:15], s53 offen lds
    ds_read_b128 v[228:231], v33 offset:32768
    ds_read_b64_tr_b16 v[96:97], v5 offset:40960
    ds_read_b64_tr_b16 v[98:99], v5 offset:41216
    v_mfma_f32_32x32x16_bf16 v[64:79], v[100:103], v[212:215], v[64:79]
    s_add_u32 m0, s55, 0x4000
    s_add_u32 s53, s53, s52
    buffer_load_dwordx4 v3, s[12:15], s54 offen lds
    s_add_u32 s55, s55, 1024
    ds_read_b128 v[232:235], v34 offset:32768
    ds_read_b64_tr_b16 v[100:101], v6 offset:40960
    ds_read_b64_tr_b16 v[102:103], v6 offset:41216
    v_mfma_f32_32x32x16_bf16 v[64:79], v[104:107], v[216:219], v[64:79]
    v_mfma_f32_16x16x32_bf16 v[44:47], v[16:19], v[216:219], v[44:47]
    v_dot2c_f32_bf16 v48, v216, v216
    v_dot2c_f32_bf16 v49, v217, v217
    v_dot2c_f32_bf16 v48, v218, v218
    v_dot2c_f32_bf16 v49, v219, v219
    s_mov_b32 m0, s55
    s_add_u32 s54, s53, 64
    buffer_load_dwordx4 v3, s[12:15], s53 offen lds
    ds_read_b128 v[236:239], v35 offset:32768
    ds_read_b64_tr_b16 v[104:105], v7 offset:40960
    ds_read_b64_tr_b16 v[106:107], v7 offset:41216
    v_mfma_f32_32x32x16_bf16 v[64:79], v[108:111], v[220:223], v[64:79]
    s_add_u32 m0, s55, 0x4000
    s_add_u32 s53, s53, s52
    buffer_load_dwordx4 v3, s[12:15], s54 offen lds
    s_add_u32 s55, s55, 1024
    ds_read_b128 v[240:243], v36 offset:32768
    ds_read_b64_tr_b16 v[108:109], v4 offset:45056
    ds_read_b64_tr_b16 v[110:111], v4 offset:45312
    s_waitcnt lgkmcnt(12)
    v_mfma_f32_32x32x16_bf16 v[64:79], v[112:115], v[224:227], v[64:79]
    v_mfma_f32_16x16x32_bf16 v[20:23], v[16:19], v[112:115], v[20:23]
    v_mfma_f32_16x16x32_bf16 v[44:47], v[16:19], v[224:227], v[44:47]
    v_dot2c_f32_bf16 v48, v224, v224
    v_dot2c_f32_bf16 v49, v225, v225
    v_dot2c_f32_bf16 v48, v226, v226
    v_dot2c_f32_bf16 v49, v227, v227
    s_cmp_eq_u32 s29, 0
    s_cbranch_scc1 K_AUXQ
    buffer_load_ushort v116, v50, s[20:23], s44 offen
    buffer_load_ushort v117, v50, s[20:23], s45 offen
    buffer_load_ushort v118, v50, s[20:23], s46 offen
    buffer_load_ushort v119, v50, s[20:23], s47 offen
    s_branch K_AUXD
K_AUXQ:
    s_lshl_b32 m0, s24, 10
    s_nop 0
    buffer_load_dwordx4 v50, s[20:23], 0 offen lds
K_AUXD:
    ds_read_b128 v[244:247], v37 offset:32768
    ds_read_b64_tr_b16 v[112:113], v5 offset:45056
    ds_read_b64_tr_b16 v[114:115], v5 offset:45312
    s_waitcnt lgkmcnt(12)
    v_mfma_f32_32x32x16_bf16 v[64:79], v[96:99], v[228:231], v[64:79]
    s_cmp_eq_u32 s29, 0
    s_cbranch_scc1 K_NP1
    s_lshl_b32 s38, s28, 3
    s_add_u32 s38, s38, s27
    s_lshl_b32 s38, s38, 14
    s_lshl_b32 s39, s24, 10
    s_add_u32 s40, s38, s39
    s_add_u32 s40, s40, 20971520
    buffer_store_dwordx4 v[52:55], v2, s[16:19], s40 offen sc1
    s_cmp_lg_u32 s24, 7
    s_cbranch_scc1 K_NP1
    s_lshl_b32 s38, s27, 4
    s_add_u32 s38, s38, s28
    s_lshl_b32 s38, s38, 9
    s_add_u32 s38, s38, 23068672
    s_mov_b32 exec_hi, 0
    buffer_store_dwordx4 v[52:55], v2, s[16:19], s38 offen sc1
    buffer_store_dwordx4 v[52:55], v2, s[16:19], s40 offen offset:1024 sc1
    s_mov_b32 exec_hi, -1
K_NP1:
    ds_read_b128 v[248:251], v38 offset:32768
    ds_read_b64_tr_b16 v[96:97], v6 offset:45056
    ds_read_b64_tr_b16 v[98:99], v6 offset:45312
    s_waitcnt lgkmcnt(12)
    v_mfma_f32_32x32x16_bf16 v[64:79], v[100:103], v[232:235], v[64:79]
    v_mfma_f32_16x16x32_bf16 v[44:47], v[16:19], v[232:235], v[44:47]
    v_dot2c_f32_bf16 v48, v232, v232
    v_dot2c_f32_bf16 v49, v233, v233
    v_dot2c_f32_bf16 v48, v234, v234
    v_dot2c_f32_bf16 v49, v235, v235
    s_cmp_eq_u32 s29, 0
    s_cbranch_scc1 K_NP2
    s_lshl_b32 s38, s31, 16
    s_lshl_b32 s39, s27, 13
    s_add_u32 s38, s38, s39
    s_lshl_b32 s39, s26, 12
    s_add_u32 s38, s38, s39
    s_add_u32 s38, s38, 16777216
    buffer_store_dwordx4 v[52:55], v127, s[16:19], s38 offen sc1
    buffer_store_dwordx4 v[52:55], v127, s[16:19], s38 offen offset:2048 sc1
K_NP2:
    ds_read_b128 v[252:255], v39 offset:32768
    ds_read_b64_tr_b16 v[100:101], v7 offset:45056
    ds_read_b64_tr_b16 v[102:103], v7 offset:45312
    s_waitcnt lgkmcnt(12)
    v_mfma_f32_32x32x16_bf16 v[64:79], v[104:107], v[236:239], v[64:79]
    s_waitcnt vmcnt(63) lgkmcnt(0)
    s_barrier
    v_mfma_f32_32x32x16_bf16 v[64:79], v[108:111], v[240:243], v[64:79]
    v_mfma_f32_16x16x32_bf16 v[20:23], v[16:19], v[108:111], v[20:23]
    v_mfma_f32_16x16x32_bf16 v[44:47], v[16:19], v[240:243], v[44:47]
    v_dot2c_f32_bf16 v48, v240, v240
    v_dot2c_f32_bf16 v49, v241, v241
    v_dot2c_f32_bf16 v48, v242, v242
    v_dot2c_f32_bf16 v49, v243, v243
    v_mfma_f32_32x32x16_bf16 v[64:79], v[112:115], v[244:247], v[64:79]
    v_mfma_f32_32x32x16_bf16 v[64:79], v[96:99], v[248:251], v[64:79]
    v_mfma_f32_16x16x32_bf16 v[44:47], v[16:19], v[248:251], v[44:47]
    v_dot2c_f32_bf16 v48, v248, v248
    v_dot2c_f32_bf16 v49, v249, v249
    v_dot2c_f32_bf16 v48, v250, v250
    v_dot2c_f32_bf16 v49, v251, v251
    v_mfma_f32_32x32x16_bf16 v[80:95], v[100:103], v[252:255], v[64:79]
    v_and_b32 v33, 31, v1
    s_lshl_b32 s38, s24, 8
    s_add_u32 s38, s38, 131072
    v_add_f32 v48, v48, v49
    v_mov_b32 v49, v48
    v_lshl_add_u32 v32, v33, 3, s38
    v_lshlrev_b32 v34, 2, v33
    v_permlane32_swap_b32 v48, v49
    v_add_f32 v45, v48, v49
    ds_write_b64 v32, v[44:45]
    ds_write_b32 v14, v20
    v_add_u32 v33, 0x21400, v34
    ds_write_b32 v33, v28
    v_xor_b32 v32, 1024, v32
    v_xor_b32 v4, 0x10000, v4
    v_xor_b32 v5, 0x10000, v5
    v_xor_b32 v6, 0x10000, v6
    v_xor_b32 v7, 0x10000, v7
    v_xor_b32 v14, 1024, v14
    v_cmp_gt_u32 vcc, 32, v1
    s_cmp_eq_u32 s29, 0
    s_cbranch_scc1 K_QKV
    s_waitcnt vmcnt(0) lgkmcnt(0)
    s_barrier
    s_cmp_lg_u32 s24, 7
    s_cbranch_scc1 K_NA
    s_and_b32 s38, s2, 1
    s_lshl_b32 s38, s38, 7
    v_mov_b32 v0, 1
    s_mov_b64 exec, 1
    buffer_atomic_add v0, v28, s[4:7], s38 offen sc1
    s_mov_b64 exec, -1
K_NA:
    s_lshl_b32 s61, s44, 6
    s_add_u32 s61, s61, s50
    s_add_u32 s53, s56, s46
    s_mov_b32 s55, s42
    ds_read_b128 v[48:51], v15
    ds_read_b64 v[8:9], v32
    ds_read_b64_tr_b16 v[96:97], v4 offset:0
    ds_read_b64_tr_b16 v[98:99], v4 offset:256
    ds_read_b64_tr_b16 v[100:101], v5 offset:0
    ds_read_b64_tr_b16 v[102:103], v5 offset:256
    ds_read_b64_tr_b16 v[104:105], v6 offset:0
    ds_read_b64_tr_b16 v[106:107], v6 offset:256
    ds_read_b64_tr_b16 v[108:109], v7 offset:0
    ds_read_b64_tr_b16 v[110:111], v7 offset:256
    ds_read_b64_tr_b16 v[112:113], v4 offset:4096
    ds_read_b64_tr_b16 v[114:115], v4 offset:4352
    s_waitcnt lgkmcnt(8)
    v_mfma_f32_32x32x16_bf16 v[64:79], v[96:99], v[128:131], 0
    v_mfma_f32_16x16x32_bf16 v[20:23], v[16:19], v[96:99], 0
    s_mov_b32 m0, s55
    s_add_u32 s54, s53, 64
    buffer_load_dwordx4 v3, s[12:15], s53 offen lds
    v_add_f32 v8, v8, v44
    v_add_f32 v9, v9, v45
    v_mul_f32 v8, 0xbb000000, v8
    v_mul_f32 v9, 0x3b000000, v9
    v_fma_f32 v9, -v8, v8, v9
    ds_read_b64_tr_b16 v[96:97], v5 offset:4096
    ds_read_b64_tr_b16 v[98:99], v5 offset:4352
    s_waitcnt lgkmcnt(8)
    v_mfma_f32_32x32x16_bf16 v[64:79], v[100:103], v[132:135], v[64:79]
    v_cvt_pk_bf16_f32 v26, v8, v8
    v_max_f32 v9, 0, v9
    v_cvt_pk_bf16_f32 v9, v9, v9
    s_add_u32 m0, s55, 0x4000
    s_add_u32 s53, s53, s52
    buffer_load_dwordx4 v3, s[12:15], s54 offen lds
    s_add_u32 s55, s55, 1024
    v_and_b32 v9, s37, v9
    v_add_f32 v9, 0x3727c5ac, v9
    ds_read_b64_tr_b16 v[100:101], v6 offset:4096
    ds_read_b64_tr_b16 v[102:103], v6 offset:4352
    s_waitcnt lgkmcnt(8)
    v_mfma_f32_32x32x16_bf16 v[64:79], v[104:107], v[136:139], v[64:79]
    v_cvt_pk_bf16_f32 v9, v9, v9
    v_and_b32 v9, s37, v9
    v_sqrt_f32 v9, v9
    v_cndmask_b32 v26, 0, v26, vcc
    v_cvt_pk_bf16_f32 v27, v8, v9
    v_and_b32 v9, s37, v27
    ds_read_b64_tr_b16 v[104:105], v7 offset:4096
    ds_read_b64_tr_b16 v[106:107], v7 offset:4352
    s_waitcnt lgkmcnt(8)
    v_mfma_f32_32x32x16_bf16 v[64:79], v[108:111], v[140:143], v[64:79]
    s_mov_b32 m0, s55
    s_add_u32 s54, s53, 64
    buffer_load_dwordx4 v3, s[12:15], s53 offen lds
    v_rcp_f32 v8, v9
    v_cndmask_b32 v27, 0, v27, vcc
    v_mov_b32 v124, v9
    v_mul_f32 v31, 0xc0135761, v8
    v_mul_f32 v30, v8, v8
    ds_read_b64_tr_b16 v[108:109], v4 offset:8192
    ds_read_b64_tr_b16 v[110:111], v4 offset:8448
    s_waitcnt lgkmcnt(8)
    v_mfma_f32_32x32x16_bf16 v[64:79], v[112:115], v[144:147], v[64:79]
    v_mfma_f32_16x16x32_bf16 v[20:23], v[16:19], v[112:115], v[20:23]
    v_mul_f32 v30, v30, v31
    v_mul_f32 v30, 0x3d372713, v30
    v_lshlrev_b32 v116, 16, v116
    v_lshlrev_b32 v117, 16, v117
    s_add_u32 m0, s55, 0x4000
    s_add_u32 s53, s53, s76
    buffer_load_dwordx4 v3, s[12:15], s54 offen lds
    s_add_u32 s55, s55, 0x7c00
    v_lshlrev_b32 v118, 16, v118
    ds_read_b64_tr_b16 v[112:113], v5 offset:8192
    ds_read_b64_tr_b16 v[114:115], v5 offset:8448
    s_waitcnt lgkmcnt(8)
    v_mfma_f32_32x32x16_bf16 v[64:79], v[96:99], v[148:151], v[64:79]
    v_lshlrev_b32 v119, 16, v119
    v_add_f32 v48, v48, v49
    v_add_f32 v50, v50, v51
    v_add_f32 v48, v48, v50
    v_cvt_pk_bf16_f32 v49, v48, v48
    v_and_b32 v49, s37, v49
    v_sub_f32 v49, v48, v49
    ds_read_b64_tr_b16 v[96:97], v6 offset:8192
    ds_read_b64_tr_b16 v[98:99], v6 offset:8448
    s_waitcnt lgkmcnt(8)
    v_mfma_f32_32x32x16_bf16 v[64:79], v[100:103], v[152:155], v[64:79]
    s_mov_b32 m0, s55
    s_add_u32 s54, s53, 64
    buffer_load_dwordx4 v3, s[12:15], s53 offen lds
    v_cvt_pk_bf16_f32 v24, v48, v49
    v_and_b32 v48, s37, v24
    v_sub_f32 v49, v49, v48
    v_cvt_pk_bf16_f32 v25, v49, v116
    ds_read_b64_tr_b16 v[100:101], v7 offset:8192
    ds_read_b64_tr_b16 v[102:103], v7 offset:8448
    s_waitcnt lgkmcnt(8)
    v_mfma_f32_32x32x16_bf16 v[64:79], v[104:107], v[156:159], v[64:79]
    s_nop 1
    v_mfma_f32_32x32x16_bf16 v[80:95], v[24:27], v[26:29], v[80:95]
    ds_read_b64_tr_b16 v[104:105], v4 offset:12288
    ds_read_b64_tr_b16 v[106:107], v4 offset:12544
    s_waitcnt lgkmcnt(8)
    v_mfma_f32_32x32x16_bf16 v[64:79], v[108:111], v[160:163], v[64:79]
    v_mfma_f32_16x16x32_bf16 v[20:23], v[16:19], v[108:111], v[20:23]
    s_add_u32 m0, s55, 0x4000
    s_add_u32 s53, s53, s52
    buffer_load_dwordx4 v3, s[12:15], s54 offen lds
    s_add_u32 s55, s55, 1024
    s_nop 2
    v_mul_f32 v32, v80, v80
    v_mul_f32 v33, v81, v81
    v_mul_f32 v34, v82, v82
    v_mul_f32 v35, v83, v83
    v_mul_f32 v36, v84, v84
    ds_read_b64_tr_b16 v[108:109], v5 offset:12288
    ds_read_b64_tr_b16 v[110:111], v5 offset:12544
    s_waitcnt lgkmcnt(8)
    v_mfma_f32_32x32x16_bf16 v[64:79], v[112:115], v[164:167], v[64:79]
    v_mul_f32 v37, v85, v85
    v_mul_f32 v38, v86, v86
    s_mov_b32 m0, s55
    s_add_u32 s54, s53, 64
    buffer_load_dwordx4 v3, s[12:15], s53 offen lds
    v_mul_f32 v39, v87, v87
    v_fma_f32 v32, v32, v30, v31
    v_fma_f32 v33, v33, v30, v31
    ds_read_b64_tr_b16 v[112:113], v6 offset:12288
    ds_read_b64_tr_b16 v[114:115], v6 offset:12544
    s_waitcnt lgkmcnt(8)
    v_mfma_f32_32x32x16_bf16 v[64:79], v[96:99], v[168:171], v[64:79]
    v_fma_f32 v34, v34, v30, v31
    v_fma_f32 v35, v35, v30, v31
    v_fma_f32 v36, v36, v30, v31
    v_fma_f32 v37, v37, v30, v31
    v_fma_f32 v38, v38, v30, v31
    v_fma_f32 v39, v39, v30, v31
    s_add_u32 m0, s55, 0x4000
    s_add_u32 s53, s53, s52
    buffer_load_dwordx4 v3, s[12:15], s54 offen lds
    s_add_u32 s55, s55, 1024
    ds_read_b64_tr_b16 v[96:97], v7 offset:12288
    ds_read_b64_tr_b16 v[98:99], v7 offset:12544
    s_waitcnt lgkmcnt(8)
    v_mfma_f32_32x32x16_bf16 v[64:79], v[100:103], v[172:175], v[64:79]
    v_mul_f32 v32, v80, v32
    v_mul_f32 v33, v81, v33
    v_mul_f32 v34, v82, v34
    v_mul_f32 v35, v83, v35
    v_mul_f32 v36, v84, v36
    v_mul_f32 v37, v85, v37
    v_mul_f32 v38, v86, v38
    ds_read_b64_tr_b16 v[100:101], v4 offset:32768
    ds_read_b64_tr_b16 v[102:103], v4 offset:33024
    s_waitcnt lgkmcnt(8)
    v_mfma_f32_32x32x16_bf16 v[64:79], v[104:107], v[176:179], v[64:79]
    v_mfma_f32_16x16x32_bf16 v[20:23], v[16:19], v[104:107], v[20:23]
    v_mul_f32 v39, v87, v39
    v_exp_f32 v32, v32
    v_exp_f32 v33, v33
    v_exp_f32 v34, v34
    ds_read_b64_tr_b16 v[104:105], v5 offset:32768
    ds_read_b64_tr_b16 v[106:107], v5 offset:33024
    s_waitcnt lgkmcnt(8)
    v_mfma_f32_32x32x16_bf16 v[64:79], v[108:111], v[180:183], v[64:79]
    v_exp_f32 v35, v35
    v_exp_f32 v36, v36
    s_lshl_b32 s38, s45, 6
    s_add_u32 s38, s38, s50
    buffer_store_dwordx4 v[52:55], v127, s[16:19], s38 offen offset:0 sc1
    v_exp_f32 v37, v37
    ds_read_b64_tr_b16 v[108:109], v6 offset:32768
    ds_read_b64_tr_b16 v[110:111], v6 offset:33024
    s_waitcnt lgkmcnt(8)
    v_mfma_f32_32x32x16_bf16 v[64:79], v[112:115], v[184:187], v[64:79]
    v_exp_f32 v38, v38
    v_exp_f32 v39, v39
    v_fma_f32 v32, v32, v124, v124
    v_fma_f32 v33, v33, v124, v124
    v_fma_f32 v34, v34, v124, v124
    v_fma_f32 v35, v35, v124, v124
    ds_read_b64_tr_b16 v[112:113], v7 offset:32768
    ds_read_b64_tr_b16 v[114:115], v7 offset:33024
    s_waitcnt lgkmcnt(8)
    v_mfma_f32_32x32x16_bf16 v[64:79], v[96:99], v[188:191], v[64:79]
    v_fma_f32 v36, v36, v124, v124
    v_fma_f32 v37, v37, v124, v124
    v_fma_f32 v38, v38, v124, v124
    v_fma_f32 v39, v39, v124, v124
    v_rcp_f32 v32, v32
    v_rcp_f32 v33, v33
    ds_read_b64_tr_b16 v[96:97], v4 offset:36864
    ds_read_b64_tr_b16 v[98:99], v4 offset:37120
    s_waitcnt lgkmcnt(8)
    v_mfma_f32_32x32x16_bf16 v[64:79], v[100:103], v[192:195], v[64:79]
    v_mfma_f32_16x16x32_bf16 v[20:23], v[16:19], v[100:103], v[20:23]
    v_rcp_f32 v34, v34
    v_rcp_f32 v35, v35
    v_rcp_f32 v36, v36
    s_lshl_b32 s38, s45, 6
    s_add_u32 s38, s38, s50
    buffer_store_dwordx4 v[52:55], v127, s[16:19], s38 offen offset:2048 sc1
    ds_read_b64_tr_b16 v[100:101], v5 offset:36864
    ds_read_b64_tr_b16 v[102:103], v5 offset:37120
    s_waitcnt lgkmcnt(8)
    v_mfma_f32_32x32x16_bf16 v[64:79], v[104:107], v[196:199], v[64:79]
    v_rcp_f32 v37, v37
    v_rcp_f32 v38, v38
    v_rcp_f32 v39, v39
    v_mul_f32 v32, v80, v32
    v_mul_f32 v33, v81, v33
    ds_read_b64_tr_b16 v[104:105], v6 offset:36864
    ds_read_b64_tr_b16 v[106:107], v6 offset:37120
    s_waitcnt lgkmcnt(8)
    v_mfma_f32_32x32x16_bf16 v[64:79], v[108:111], v[200:203], v[64:79]
    v_mul_f32 v34, v82, v34
    v_mul_f32 v35, v83, v35
    v_mul_f32 v36, v84, v36
    v_mul_f32 v37, v85, v37
    v_mul_f32 v38, v86, v38
    v_mul_f32 v39, v87, v39
    v_cvt_pk_bf16_f32 v56, v32, v33
    ds_read_b64_tr_b16 v[108:109], v7 offset:36864
    ds_read_b64_tr_b16 v[110:111], v7 offset:37120
    s_waitcnt lgkmcnt(8)
    v_mfma_f32_32x32x16_bf16 v[64:79], v[112:115], v[204:207], v[64:79]
    v_cvt_pk_bf16_f32 v57, v34, v35
    v_cvt_pk_bf16_f32 v58, v36, v37
    v_cvt_pk_bf16_f32 v59, v38, v39
    s_lshl_b32 s38, s46, 6
    s_add_u32 s38, s38, s50
    buffer_store_dwordx4 v[52:55], v127, s[16:19], s38 offen offset:0 sc1
    buffer_store_dwordx4 v[56:59], v127, s[16:19], s61 offen offset:0 sc1
    ds_read_b64_tr_b16 v[112:113], v4 offset:40960
    ds_read_b64_tr_b16 v[114:115], v4 offset:41216
    s_waitcnt lgkmcnt(8)
    v_mfma_f32_32x32x16_bf16 v[64:79], v[96:99], v[208:211], v[64:79]
    v_mfma_f32_16x16x32_bf16 v[20:23], v[16:19], v[96:99], v[20:23]
    v_mul_f32 v40, v88, v88
    v_mul_f32 v41, v89, v89
    v_mul_f32 v42, v90, v90
    v_mul_f32 v43, v91, v91
    v_mul_f32 v44, v92, v92
    v_mul_f32 v45, v93, v93
    v_mul_f32 v46, v94, v94
    ds_read_b64_tr_b16 v[96:97], v5 offset:40960
    ds_read_b64_tr_b16 v[98:99], v5 offset:41216
    s_waitcnt lgkmcnt(8)
    v_mfma_f32_32x32x16_bf16 v[64:79], v[100:103], v[212:215], v[64:79]
    v_mul_f32 v47, v95, v95
    v_fma_f32 v40, v40, v30, v31
    v_fma_f32 v41, v41, v30, v31
    v_fma_f32 v42, v42, v30, v31
    v_fma_f32 v43, v43, v30, v31
    v_fma_f32 v44, v44, v30, v31
    v_fma_f32 v45, v45, v30, v31
    v_fma_f32 v46, v46, v30, v31
    ds_read_b64_tr_b16 v[100:101], v6 offset:40960
    ds_read_b64_tr_b16 v[102:103], v6 offset:41216
    s_waitcnt lgkmcnt(8)
    v_mfma_f32_32x32x16_bf16 v[64:79], v[104:107], v[216:219], v[64:79]
    s_lshl_b32 s38, s46, 6
    s_add_u32 s38, s38, s50
    buffer_store_dwordx4 v[52:55], v127, s[16:19], s38 offen offset:2048 sc1
    v_fma_f32 v47, v47, v30, v31
    v_mul_f32 v40, v88, v40
    v_mul_f32 v41, v89, v41
    v_mul_f32 v42, v90, v42
    v_mul_f32 v43, v91, v43
    ds_read_b64_tr_b16 v[104:105], v7 offset:40960
    ds_read_b64_tr_b16 v[106:107], v7 offset:41216
    s_waitcnt lgkmcnt(8)
    v_mfma_f32_32x32x16_bf16 v[64:79], v[108:111], v[220:223], v[64:79]
    v_mul_f32 v44, v92, v44
    v_mul_f32 v45, v93, v45
    v_mul_f32 v46, v94, v46
    v_mul_f32 v47, v95, v47
    v_exp_f32 v40, v40
    v_exp_f32 v41, v41
    ds_read_b64_tr_b16 v[108:109], v4 offset:45056
    ds_read_b64_tr_b16 v[110:111], v4 offset:45312
    s_waitcnt lgkmcnt(8)
    v_mfma_f32_32x32x16_bf16 v[64:79], v[112:115], v[224:227], v[64:79]
    v_mfma_f32_16x16x32_bf16 v[20:23], v[16:19], v[112:115], v[20:23]
    v_exp_f32 v42, v42
    v_exp_f32 v43, v43
    v_exp_f32 v44, v44
    v_exp_f32 v45, v45
    ds_read_b64_tr_b16 v[112:113], v5 offset:45056
    ds_read_b64_tr_b16 v[114:115], v5 offset:45312
    s_waitcnt lgkmcnt(8)
    v_mfma_f32_32x32x16_bf16 v[64:79], v[96:99], v[228:231], v[64:79]
    v_exp_f32 v46, v46
    buffer_store_dwordx4 v[52:55], v127, s[16:19], s48 offen sc1
    v_exp_f32 v47, v47
    v_fma_f32 v40, v40, v124, v124
    v_fma_f32 v41, v41, v124, v124
    ds_read_b64_tr_b16 v[96:97], v6 offset:45056
    ds_read_b64_tr_b16 v[98:99], v6 offset:45312
    s_waitcnt lgkmcnt(8)
    v_mfma_f32_32x32x16_bf16 v[64:79], v[100:103], v[232:235], v[64:79]
    v_fma_f32 v42, v42, v124, v124
    v_fma_f32 v43, v43, v124, v124
    s_cmp_lg_u32 s24, 7
    s_cbranch_scc1 K_FE1
    v_lshlrev_b32 v12, 7, v1
    s_mov_b64 exec, 3
    buffer_load_dword v13, v12, s[4:7], 0 offen sc1
    s_mov_b64 exec, -1
K_FE1:
    v_fma_f32 v44, v44, v124, v124
    v_fma_f32 v45, v45, v124, v124
    v_fma_f32 v46, v46, v124, v124
    ds_read_b64_tr_b16 v[100:101], v7 offset:45056
    ds_read_b64_tr_b16 v[102:103], v7 offset:45312
    s_waitcnt lgkmcnt(8)
    v_mfma_f32_32x32x16_bf16 v[64:79], v[104:107], v[236:239], v[64:79]
    v_fma_f32 v47, v47, v124, v124
    v_rcp_f32 v40, v40
    v_rcp_f32 v41, v41
    v_rcp_f32 v42, v42
    s_waitcnt lgkmcnt(6)
    v_mfma_f32_32x32x16_bf16 v[64:79], v[108:111], v[240:243], v[64:79]
    v_mfma_f32_16x16x32_bf16 v[20:23], v[16:19], v[108:111], v[20:23]
    v_rcp_f32 v43, v43
    v_rcp_f32 v44, v44
    v_rcp_f32 v45, v45
    v_rcp_f32 v46, v46
    v_rcp_f32 v47, v47
    s_waitcnt lgkmcnt(4)
    v_mfma_f32_32x32x16_bf16 v[64:79], v[112:115], v[244:247], v[64:79]
    v_mul_f32 v40, v88, v40
    v_mul_f32 v41, v89, v41
    v_mul_f32 v42, v90, v42
    v_mul_f32 v43, v91, v43
    v_mul_f32 v44, v92, v44
    v_mul_f32 v45, v93, v45
    s_waitcnt lgkmcnt(2)
    v_mfma_f32_32x32x16_bf16 v[64:79], v[96:99], v[248:251], v[64:79]
    v_mul_f32 v46, v94, v46
    v_mul_f32 v47, v95, v47
    v_cvt_pk_bf16_f32 v60, v40, v41
    v_cvt_pk_bf16_f32 v61, v42, v43
    v_cvt_pk_bf16_f32 v62, v44, v45
    v_cvt_pk_bf16_f32 v63, v46, v47
    buffer_store_dwordx4 v[60:63], v127, s[16:19], s61 offen offset:2048 sc1
    s_waitcnt lgkmcnt(0)
    v_mfma_f32_32x32x16_bf16 v[80:95], v[100:103], v[252:255], v[64:79]
    v_xor_b32 v4, 0x10000, v4
    v_xor_b32 v5, 0x10000, v5
    v_xor_b32 v6, 0x10000, v6
    v_xor_b32 v7, 0x10000, v7
    ds_write_b32 v14, v20
    v_xor_b32 v14, 1024, v14
    v_xor_b32 v15, 1024, v15
    s_lshl_b32 s61, s45, 6
    s_add_u32 s61, s61, s50
    s_add_u32 s53, s56, s51
    s_add_u32 s55, s42, 65536
    s_cmp_lg_u32 s77, 0
    s_cselect_b64 vcc, -1, 0
    s_waitcnt vmcnt(7) lgkmcnt(0)
    s_cmp_lg_u32 s24, 7
    s_cbranch_scc1 X1
    s_waitcnt vmcnt(1)
    s_mov_b32 s3, 0
C2:
    s_movk_i32 s39, 64
    v_cmp_gt_u32 s[62:63], s39, v13
    s_nop 0
    s_and_b32 s38, s62, 0x3
    s_cbranch_scc0 C3
    s_sleep 8
    v_lshlrev_b32 v12, 7, v1
    s_mov_b64 exec, 3
    buffer_load_dword v13, v12, s[4:7], 0 offen sc1
    s_mov_b64 exec, -1
    s_add_u32 s3, s3, 1
    s_cmp_lt_u32 s3, 20000
    s_waitcnt vmcnt(0)
    s_cbranch_scc1 C2
C3:
X1:
    s_barrier
    ds_read_b128 v[48:51], v15
    ds_read_b64_tr_b16 v[96:97], v4 offset:0
    ds_read_b64_tr_b16 v[98:99], v4 offset:256
    ds_read_b64_tr_b16 v[100:101], v5 offset:0
    ds_read_b64_tr_b16 v[102:103], v5 offset:256
    ds_read_b64_tr_b16 v[104:105], v6 offset:0
    ds_read_b64_tr_b16 v[106:107], v6 offset:256
    ds_read_b64_tr_b16 v[108:109], v7 offset:0
    ds_read_b64_tr_b16 v[110:111], v7 offset:256
    ds_read_b64_tr_b16 v[112:113], v4 offset:4096
    ds_read_b64_tr_b16 v[114:115], v4 offset:4352
    s_waitcnt lgkmcnt(8)
    v_mfma_f32_32x32x16_bf16 v[64:79], v[96:99], v[128:131], 0
    v_mfma_f32_16x16x32_bf16 v[20:23], v[16:19], v[96:99], 0
    s_mov_b32 m0, s55
    s_add_u32 s55, s55, 1024
    buffer_load_dwordx4 v3, s[12:15], s53 offen lds
    s_add_u32 s53, s53, s52
    v_add_f32 v48, v48, v49
    v_add_f32 v50, v50, v51
    v_add_f32 v48, v48, v50
    v_cvt_pk_bf16_f32 v49, v48, v48
    ds_read_b64_tr_b16 v[96:97], v5 offset:4096
    ds_read_b64_tr_b16 v[98:99], v5 offset:4352
    s_waitcnt lgkmcnt(8)
    v_mfma_f32_32x32x16_bf16 v[64:79], v[100:103], v[132:135], v[64:79]
    v_and_b32 v49, s37, v49
    v_sub_f32 v49, v48, v49
    s_mov_b32 m0, s55
    s_add_u32 s55, s55, 0x7c00
    buffer_load_dwordx4 v3, s[12:15], s53 offen lds
    s_add_u32 s53, s53, s76
    v_cvt_pk_bf16_f32 v24, v48, v49
    v_and_b32 v48, s37, v24
    ds_read_b64_tr_b16 v[100:101], v6 offset:4096
    ds_read_b64_tr_b16 v[102:103], v6 offset:4352
    s_waitcnt lgkmcnt(8)
    v_mfma_f32_32x32x16_bf16 v[64:79], v[104:107], v[136:139], v[64:79]
    v_sub_f32 v49, v49, v48
    v_cvt_pk_bf16_f32 v25, v49, v117
    s_nop 1
    v_mfma_f32_32x32x16_bf16 v[80:95], v[24:27], v[26:29], v[80:95]
    s_mov_b32 m0, s55
    s_add_u32 s55, s55, 1024
    buffer_load_dwordx4 v3, s[12:15], s53 offen lds
    s_add_u32 s53, s53, s52
    ds_read_b64_tr_b16 v[104:105], v7 offset:4096
    ds_read_b64_tr_b16 v[106:107], v7 offset:4352
    s_waitcnt lgkmcnt(8)
    v_mfma_f32_32x32x16_bf16 v[64:79], v[108:111], v[140:143], v[64:79]
    s_nop 3
    ds_read_b64_tr_b16 v[108:109], v4 offset:8192
    ds_read_b64_tr_b16 v[110:111], v4 offset:8448
    s_waitcnt lgkmcnt(8)
    v_mfma_f32_32x32x16_bf16 v[64:79], v[112:115], v[144:147], v[64:79]
    v_mfma_f32_16x16x32_bf16 v[20:23], v[16:19], v[112:115], v[20:23]
    v_mul_f32 v32, v80, v80
    v_mul_f32 v33, v81, v81
    s_mov_b32 m0, s55
    s_add_u32 s55, s55, 1024
    buffer_load_dwordx4 v3, s[12:15], s53 offen lds
    s_add_u32 s53, s53, s52
    v_mul_f32 v34, v82, v82
    v_mul_f32 v35, v83, v83
    ds_read_b64_tr_b16 v[112:113], v5 offset:8192
    ds_read_b64_tr_b16 v[114:115], v5 offset:8448
    s_waitcnt lgkmcnt(8)
    v_mfma_f32_32x32x16_bf16 v[64:79], v[96:99], v[148:151], v[64:79]
    v_mul_f32 v36, v84, v84
    v_mul_f32 v37, v85, v85
    v_mul_f32 v38, v86, v86
    v_mul_f32 v39, v87, v87
    v_fma_f32 v32, v32, v30, v31
    s_add_u32 m0, s68, 81920
    s_add_u32 s38, s69, 0
    buffer_load_dwordx4 v126, s[64:67], s38 offen lds
    ds_read_b64_tr_b16 v[96:97], v6 offset:8192
    ds_read_b64_tr_b16 v[98:99], v6 offset:8448
    s_waitcnt lgkmcnt(8)
    v_mfma_f32_32x32x16_bf16 v[64:79], v[100:103], v[152:155], v[64:79]
    v_fma_f32 v33, v33, v30, v31
    v_fma_f32 v34, v34, v30, v31
    v_fma_f32 v35, v35, v30, v31
    v_fma_f32 v36, v36, v30, v31
    v_fma_f32 v37, v37, v30, v31
    v_fma_f32 v38, v38, v30, v31
    ds_read_b64_tr_b16 v[100:101], v7 offset:8192
    ds_read_b64_tr_b16 v[102:103], v7 offset:8448
    s_waitcnt lgkmcnt(8)
    v_mfma_f32_32x32x16_bf16 v[64:79], v[104:107], v[156:159], v[64:79]
    s_add_u32 m0, s68, 90112
    s_add_u32 s38, s69, 16384
    buffer_load_dwordx4 v126, s[64:67], s38 offen lds
    v_fma_f32 v39, v39, v30, v31
    v_mul_f32 v32, v80, v32
    v_mul_f32 v33, v81, v33
    v_mul_f32 v34, v82, v34
    ds_read_b64_tr_b16 v[104:105], v4 offset:12288
    ds_read_b64_tr_b16 v[106:107], v4 offset:12544
    s_waitcnt lgkmcnt(8)
    v_mfma_f32_32x32x16_bf16 v[64:79], v[108:111], v[160:163], v[64:79]
    v_mfma_f32_16x16x32_bf16 v[20:23], v[16:19], v[108:111], v[20:23]
    v_mul_f32 v35, v83, v35
    v_mul_f32 v36, v84, v36
    s_add_u32 m0, s68, 114688
    s_add_u32 s38, s69, 32768
    buffer_load_dwordx4 v126, s[64:67], s38 offen lds
    v_mul_f32 v37, v85, v37
    v_mul_f32 v38, v86, v38
    ds_read_b64_tr_b16 v[108:109], v5 offset:12288
    ds_read_b64_tr_b16 v[110:111], v5 offset:12544
    s_waitcnt lgkmcnt(8)
    v_mfma_f32_32x32x16_bf16 v[64:79], v[112:115], v[164:167], v[64:79]
    v_mul_f32 v39, v87, v39
    v_exp_f32 v32, v32
    v_exp_f32 v33, v33
    v_exp_f32 v34, v34
    ds_read_b64_tr_b16 v[112:113], v6 offset:12288
    ds_read_b64_tr_b16 v[114:115], v6 offset:12544
    s_waitcnt lgkmcnt(8)
    v_mfma_f32_32x32x16_bf16 v[64:79], v[96:99], v[168:171], v[64:79]
    s_waitcnt vmcnt(7)
    v_mov_b32 v125, 1
    v_lshlrev_b32 v0, 2, v1
    s_mov_b32 exec_hi, 0
    buffer_store_dword v125, v0, s[16:19], s60 offen sc1
    s_mov_b32 exec_hi, -1
    v_exp_f32 v35, v35
    ds_read_b64_tr_b16 v[96:97], v7 offset:12288
    ds_read_b64_tr_b16 v[98:99], v7 offset:12544
    s_waitcnt lgkmcnt(8)
    v_mfma_f32_32x32x16_bf16 v[64:79], v[100:103], v[172:175], v[64:79]
    v_exp_f32 v36, v36
    v_exp_f32 v37, v37
    v_exp_f32 v38, v38
    v_exp_f32 v39, v39
    ds_read_b64_tr_b16 v[100:101], v4 offset:32768
    ds_read_b64_tr_b16 v[102:103], v4 offset:33024
    s_waitcnt lgkmcnt(8)
    v_mfma_f32_32x32x16_bf16 v[64:79], v[104:107], v[176:179], v[64:79]
    v_mfma_f32_16x16x32_bf16 v[20:23], v[16:19], v[104:107], v[20:23]
    v_fma_f32 v32, v32, v124, v124
    v_fma_f32 v33, v33, v124, v124
    s_add_u32 m0, s68, 122880
    s_add_u32 s38, s69, 49152
    buffer_load_dwordx4 v126, s[64:67], s38 offen lds
    v_fma_f32 v34, v34, v124, v124
    v_fma_f32 v35, v35, v124, v124
    ds_read_b64_tr_b16 v[104:105], v5 offset:32768
    ds_read_b64_tr_b16 v[106:107], v5 offset:33024
    s_waitcnt lgkmcnt(8)
    v_mfma_f32_32x32x16_bf16 v[64:79], v[108:111], v[180:183], v[64:79]
    v_fma_f32 v36, v36, v124, v124
    v_fma_f32 v37, v37, v124, v124
    v_fma_f32 v38, v38, v124, v124
    v_fma_f32 v39, v39, v124, v124
    s_add_u32 m0, s68, 139264
    s_add_u32 s38, s69, 262144
    buffer_load_dwordx4 v126, s[64:67], s38 offen lds
    ds_read_b64_tr_b16 v[108:109], v6 offset:32768
    ds_read_b64_tr_b16 v[110:111], v6 offset:33024
    s_waitcnt lgkmcnt(8)
    v_mfma_f32_32x32x16_bf16 v[64:79], v[112:115], v[184:187], v[64:79]
    v_rcp_f32 v32, v32
    v_rcp_f32 v33, v33
    v_rcp_f32 v34, v34
    v_rcp_f32 v35, v35
    ds_read_b64_tr_b16 v[112:113], v7 offset:32768
    ds_read_b64_tr_b16 v[114:115], v7 offset:33024
    s_waitcnt lgkmcnt(8)
    v_mfma_f32_32x32x16_bf16 v[64:79], v[96:99], v[188:191], v[64:79]
    v_rcp_f32 v36, v36
    v_rcp_f32 v37, v37
    s_add_u32 m0, s68, 147456
    s_add_u32 s38, s69, 278528
    buffer_load_dwordx4 v126, s[64:67], s38 offen lds
    ds_read_b64_tr_b16 v[96:97], v4 offset:36864
    ds_read_b64_tr_b16 v[98:99], v4 offset:37120
    s_waitcnt lgkmcnt(8)
    v_mfma_f32_32x32x16_bf16 v[64:79], v[100:103], v[192:195], v[64:79]
    v_mfma_f32_16x16x32_bf16 v[20:23], v[16:19], v[100:103], v[20:23]
    s_barrier
    v_rcp_f32 v38, v38
    v_rcp_f32 v39, v39
    v_mul_f32 v32, v80, v32
    v_mul_f32 v33, v81, v33
    v_mul_f32 v34, v82, v34
    ds_read_b64_tr_b16 v[100:101], v5 offset:36864
    ds_read_b64_tr_b16 v[102:103], v5 offset:37120
    s_waitcnt lgkmcnt(8)
    v_mfma_f32_32x32x16_bf16 v[64:79], v[104:107], v[196:199], v[64:79]
    s_add_u32 m0, s68, 0
    s_add_u32 s38, s69, 311296
    buffer_load_dwordx4 v126, s[64:67], s38 offen lds
    v_mul_f32 v35, v83, v35
    v_mul_f32 v36, v84, v36
    s_add_u32 m0, s68, 155648
    s_add_u32 s38, s69, 294912
    buffer_load_dwordx4 v126, s[64:67], s38 offen lds
    v_mul_f32 v37, v85, v37
    v_mul_f32 v38, v86, v38
    ds_read_b64_tr_b16 v[104:105], v6 offset:36864
    ds_read_b64_tr_b16 v[106:107], v6 offset:37120
    s_waitcnt lgkmcnt(8)
    v_mfma_f32_32x32x16_bf16 v[64:79], v[108:111], v[200:203], v[64:79]
    v_mul_f32 v39, v87, v39
    v_cvt_pk_bf16_f32 v56, v32, v33
    v_cvt_pk_bf16_f32 v57, v34, v35
    v_cvt_pk_bf16_f32 v58, v36, v37
    v_cvt_pk_bf16_f32 v59, v38, v39
    buffer_store_dwordx4 v[56:59], v127, s[16:19], s61 offen offset:0 sc1
    ds_read_b64_tr_b16 v[108:109], v7 offset:36864
    ds_read_b64_tr_b16 v[110:111], v7 offset:37120
    s_waitcnt lgkmcnt(8)
    v_mfma_f32_32x32x16_bf16 v[64:79], v[112:115], v[204:207], v[64:79]
    s_add_u32 m0, s68, 8192
    s_add_u32 s38, s69, 65536
    buffer_load_dwordx4 v126, s[64:67], s38 offen lds
    v_mul_f32 v40, v88, v88
    v_mul_f32 v41, v89, v89
    v_mul_f32 v42, v90, v90
    v_mul_f32 v43, v91, v91
    v_mul_f32 v44, v92, v92
    v_mul_f32 v45, v93, v93
    ds_read_b64_tr_b16 v[112:113], v4 offset:40960
    ds_read_b64_tr_b16 v[114:115], v4 offset:41216
    s_waitcnt lgkmcnt(8)
    v_mfma_f32_32x32x16_bf16 v[64:79], v[96:99], v[208:211], v[64:79]
    v_mfma_f32_16x16x32_bf16 v[20:23], v[16:19], v[96:99], v[20:23]
    v_mul_f32 v46, v94, v94
    v_mul_f32 v47, v95, v95
    v_fma_f32 v40, v40, v30, v31
    v_fma_f32 v41, v41, v30, v31
    v_fma_f32 v42, v42, v30, v31
    v_fma_f32 v43, v43, v30, v31
    ds_read_b64_tr_b16 v[96:97], v5 offset:40960
    ds_read_b64_tr_b16 v[98:99], v5 offset:41216
    s_waitcnt lgkmcnt(8)
    v_mfma_f32_32x32x16_bf16 v[64:79], v[100:103], v[212:215], v[64:79]
    s_add_u32 m0, s68, 16384
    s_add_u32 s38, s69, 81920
    buffer_load_dwordx4 v126, s[64:67], s38 offen lds
    v_fma_f32 v44, v44, v30, v31
    v_fma_f32 v45, v45, v30, v31
    v_fma_f32 v46, v46, v30, v31
    v_fma_f32 v47, v47, v30, v31
    v_mul_f32 v40, v88, v40
    v_mul_f32 v41, v89, v41
    v_mul_f32 v42, v90, v42
    ds_read_b64_tr_b16 v[100:101], v6 offset:40960
    ds_read_b64_tr_b16 v[102:103], v6 offset:41216
    s_waitcnt lgkmcnt(8)
    v_mfma_f32_32x32x16_bf16 v[64:79], v[104:107], v[216:219], v[64:79]
    v_mul_f32 v43, v91, v43
    v_mul_f32 v44, v92, v44
    v_mul_f32 v45, v93, v45
    v_mul_f32 v46, v94, v46
    v_mul_f32 v47, v95, v47
    v_exp_f32 v40, v40
    ds_read_b64_tr_b16 v[104:105], v7 offset:40960
    ds_read_b64_tr_b16 v[106:107], v7 offset:41216
    s_waitcnt lgkmcnt(8)
    v_mfma_f32_32x32x16_bf16 v[64:79], v[108:111], v[220:223], v[64:79]
    s_add_u32 m0, s68, 24576
    s_add_u32 s38, s69, 98304
    buffer_load_dwordx4 v126, s[64:67], s38 offen lds
    v_exp_f32 v41, v41
    v_exp_f32 v42, v42
    v_exp_f32 v43, v43
    ds_read_b64_tr_b16 v[108:109], v4 offset:45056
    ds_read_b64_tr_b16 v[110:111], v4 offset:45312
    s_waitcnt lgkmcnt(8)
    v_mfma_f32_32x32x16_bf16 v[64:79], v[112:115], v[224:227], v[64:79]
    v_mfma_f32_16x16x32_bf16 v[20:23], v[16:19], v[112:115], v[20:23]
    v_exp_f32 v44, v44
    v_exp_f32 v45, v45
    v_exp_f32 v46, v46
    v_exp_f32 v47, v47
    ds_read_b64_tr_b16 v[112:113], v5 offset:45056
    ds_read_b64_tr_b16 v[114:115], v5 offset:45312
    s_waitcnt lgkmcnt(8)
    v_mfma_f32_32x32x16_bf16 v[64:79], v[96:99], v[228:231], v[64:79]
    v_fma_f32 v40, v40, v124, v124
    v_fma_f32 v41, v41, v124, v124
    v_fma_f32 v42, v42, v124, v124
    v_fma_f32 v43, v43, v124, v124
    v_fma_f32 v44, v44, v124, v124
    v_fma_f32 v45, v45, v124, v124
    ds_read_b64_tr_b16 v[96:97], v6 offset:45056
    ds_read_b64_tr_b16 v[98:99], v6 offset:45312
    s_waitcnt lgkmcnt(8)
    v_mfma_f32_32x32x16_bf16 v[64:79], v[100:103], v[232:235], v[64:79]
    v_fma_f32 v46, v46, v124, v124
    v_fma_f32 v47, v47, v124, v124
    s_cbranch_vccz G4
    s_mov_b64 exec, 0xff
    buffer_load_dword v11, v10, s[16:19], s57 offen sc1
    s_mov_b64 exec, -1
G4:
    v_rcp_f32 v40, v40
    ds_read_b64_tr_b16 v[100:101], v7 offset:45056
    ds_read_b64_tr_b16 v[102:103], v7 offset:45312
    s_waitcnt lgkmcnt(8)
    v_mfma_f32_32x32x16_bf16 v[64:79], v[104:107], v[236:239], v[64:79]
    v_rcp_f32 v41, v41
    v_rcp_f32 v42, v42
    v_rcp_f32 v43, v43
    v_rcp_f32 v44, v44
    s_waitcnt lgkmcnt(6)
    v_mfma_f32_32x32x16_bf16 v[64:79], v[108:111], v[240:243], v[64:79]
    v_mfma_f32_16x16x32_bf16 v[20:23], v[16:19], v[108:111], v[20:23]
    v_rcp_f32 v45, v45
    v_rcp_f32 v46, v46
    v_rcp_f32 v47, v47
    v_mul_f32 v40, v88, v40
    s_waitcnt lgkmcnt(4)
    v_mfma_f32_32x32x16_bf16 v[64:79], v[112:115], v[244:247], v[64:79]
    v_mul_f32 v41, v89, v41
    v_mul_f32 v42, v90, v42
    v_mul_f32 v43, v91, v43
    v_mul_f32 v44, v92, v44
    v_mul_f32 v45, v93, v45
    v_mul_f32 v46, v94, v46
    s_waitcnt lgkmcnt(2)
    v_mfma_f32_32x32x16_bf16 v[64:79], v[96:99], v[248:251], v[64:79]
    v_mul_f32 v47, v95, v47
    v_cvt_pk_bf16_f32 v60, v40, v41
    v_cvt_pk_bf16_f32 v61, v42, v43
    v_cvt_pk_bf16_f32 v62, v44, v45
    v_cvt_pk_bf16_f32 v63, v46, v47
    buffer_store_dwordx4 v[60:63], v127, s[16:19], s61 offen offset:2048 sc1
    s_waitcnt lgkmcnt(0)
    v_mfma_f32_32x32x16_bf16 v[80:95], v[100:103], v[252:255], v[64:79]
    v_xor_b32 v4, 0x10000, v4
    v_xor_b32 v5, 0x10000, v5
    v_xor_b32 v6, 0x10000, v6
    v_xor_b32 v7, 0x10000, v7
    ds_write_b32 v14, v20
    v_xor_b32 v14, 1024, v14
    v_xor_b32 v15, 1024, v15
    s_lshl_b32 s61, s46, 6
    s_add_u32 s61, s61, s50
    s_waitcnt vmcnt(1) lgkmcnt(0)
    s_barrier
    s_cbranch_vccz K_FG
    s_setprio 0
    ds_read_b128 v[48:51], v15
    s_cmp_lg_u32 s77, 0
    s_cselect_b64 vcc, -1, 0
    s_mov_b32 s12, s96
    s_mov_b32 s13, s97
    s_mov_b32 s14, 0x1c0000
    s_mov_b32 s15, 0x00020000
    s_mov_b32 s20, s98
    s_mov_b32 s21, s99
    s_mov_b32 s22, 0x80000
    s_mov_b32 s23, 0x00020000
    s_lshr_b32 s39, s32, 2
    s_lshl_b32 s39, s39, 7
    s_lshl_b32 s54, s25, 17
    s_add_u32 s54, s54, s39
    v_lshrrev_b32 v6, 3, v1
    v_lshlrev_b32 v6, 10, v6
    v_and_b32 v4, 7, v1
    v_bfe_u32 v5, v1, 4, 1
    v_lshlrev_b32 v5, 2, v5
    v_xor_b32 v5, v4, v5
    v_lshl_add_u32 v3, v5, 4, v6
    v_lshl_add_u32 v6, v4, 4, v6
    s_lshr_b32 s39, s27, 2
    s_lshl_b32 s39, s39, 1
    s_lshl_b32 s40, s28, 2
    s_add_u32 s39, s39, s40
    s_lshr_b32 s38, s39, 1
    s_and_b32 s38, s38, 6
    s_and_b32 s62, s39, 1
    s_or_b32 s38, s38, s62
    s_cmp_eq_u32 s38, 3
    s_cselect_b32 s38, 7, s38
    s_lshl_b32 s38, s38, 7
    s_add_u32 s38, s38, 640
    s_mov_b32 s62, 0xff000000
    s_mov_b32 s63, 0
    v_mov_b32 v238, s38
    v_cndmask_b32 v238, 0, v238, s[62:63]
    v_add_u32 v238, v238, v2
    s_and_b32 s38, s39, 1
    s_lshl_b32 s38, s38, 10
    v_xor_b32 v238, s38, v238
    s_add_u32 s39, s39, 1
    s_lshr_b32 s38, s39, 1
    s_and_b32 s38, s38, 6
    s_and_b32 s62, s39, 1
    s_or_b32 s38, s38, s62
    s_cmp_eq_u32 s38, 3
    s_cselect_b32 s38, 7, s38
    s_lshl_b32 s38, s38, 7
    s_add_u32 s38, s38, 640
    s_mov_b32 s62, 0xff000000
    s_mov_b32 s63, 0
    v_mov_b32 v239, s38
    v_cndmask_b32 v239, 0, v239, s[62:63]
    v_add_u32 v239, v239, v2
    s_and_b32 s38, s39, 1
    s_lshl_b32 s38, s38, 10
    v_xor_b32 v239, s38, v239
    s_waitcnt vmcnt(1) lgkmcnt(0)
    s_mov_b32 s3, 0
C5:
    s_movk_i32 s39, 1
    v_cmp_gt_u32 s[62:63], s39, v11
    s_nop 0
    s_and_b32 s38, s62, 0xff
    s_cbranch_scc0 C6
    s_sleep 8
    s_mov_b64 exec, 0xff
    buffer_load_dword v11, v10, s[16:19], s57 offen sc1
    s_mov_b64 exec, -1
    s_add_u32 s3, s3, 1
    s_cmp_lt_u32 s3, 20000
    s_waitcnt vmcnt(0)
    s_cbranch_scc1 C5
C6:
    s_add_u32 s41, s30, 0
    s_add_u32 s42, s33, 0
    buffer_load_dwordx4 v[128:131], v238, s[16:19], s41 offen offset:0 sc1
    v_add_f32 v48, v48, v49
    v_add_f32 v50, v50, v51
    v_add_f32 v48, v48, v50
    v_cvt_pk_bf16_f32 v49, v48, v48
    buffer_load_dwordx4 v[132:135], v239, s[16:19], s42 offen offset:0 sc1
    v_and_b32 v49, s37, v49
    v_sub_f32 v49, v48, v49
    v_cvt_pk_bf16_f32 v24, v48, v49
    v_and_b32 v48, s37, v24
    v_sub_f32 v49, v49, v48
    buffer_load_dwordx4 v[136:139], v238, s[16:19], s41 offen offset:2048 sc1
    v_cvt_pk_bf16_f32 v25, v49, v118
    s_nop 1
    v_mfma_f32_32x32x16_bf16 v[80:95], v[24:27], v[26:29], v[80:95]
    buffer_load_dwordx4 v[140:143], v239, s[16:19], s42 offen offset:2048 sc1
    s_nop 10
    v_mul_f32 v32, v80, v80
    v_mul_f32 v33, v81, v81
    s_add_u32 s41, s30, 4096
    s_add_u32 s42, s33, 4096
    buffer_load_dwordx4 v[144:147], v238, s[16:19], s41 offen offset:0 sc1
    v_mul_f32 v34, v82, v82
    v_mul_f32 v35, v83, v83
    v_mul_f32 v36, v84, v84
    v_mul_f32 v37, v85, v85
    v_mul_f32 v38, v86, v86
    buffer_load_dwordx4 v[148:151], v239, s[16:19], s42 offen offset:0 sc1
    v_mul_f32 v39, v87, v87
    v_fma_f32 v32, v32, v30, v31
    v_fma_f32 v33, v33, v30, v31
    v_fma_f32 v34, v34, v30, v31
    buffer_load_dwordx4 v[152:155], v238, s[16:19], s41 offen offset:2048 sc1
    v_fma_f32 v35, v35, v30, v31
    v_fma_f32 v36, v36, v30, v31
    v_fma_f32 v37, v37, v30, v31
    v_fma_f32 v38, v38, v30, v31
    v_fma_f32 v39, v39, v30, v31
    buffer_load_dwordx4 v[156:159], v239, s[16:19], s42 offen offset:2048 sc1
    v_mul_f32 v32, v80, v32
    v_mul_f32 v33, v81, v33
    v_mul_f32 v34, v82, v34
    v_mul_f32 v35, v83, v35
    s_add_u32 s41, s30, 32768
    s_add_u32 s42, s33, 32768
    buffer_load_dwordx4 v[160:163], v238, s[16:19], s41 offen offset:0 sc1
    v_mul_f32 v36, v84, v36
    v_mul_f32 v37, v85, v37
    v_mul_f32 v38, v86, v38
    v_mul_f32 v39, v87, v39
    v_exp_f32 v32, v32
    buffer_load_dwordx4 v[164:167], v239, s[16:19], s42 offen offset:0 sc1
    v_exp_f32 v33, v33
    v_exp_f32 v34, v34
    v_exp_f32 v35, v35
    v_exp_f32 v36, v36
    v_exp_f32 v37, v37
    buffer_load_dwordx4 v[168:171], v238, s[16:19], s41 offen offset:2048 sc1
    v_exp_f32 v38, v38
    v_exp_f32 v39, v39
    v_fma_f32 v32, v32, v124, v124
    v_fma_f32 v33, v33, v124, v124
    buffer_load_dwordx4 v[172:175], v239, s[16:19], s42 offen offset:2048 sc1
    v_fma_f32 v34, v34, v124, v124
    v_fma_f32 v35, v35, v124, v124
    v_fma_f32 v36, v36, v124, v124
    v_fma_f32 v37, v37, v124, v124
    v_fma_f32 v38, v38, v124, v124
    s_add_u32 s41, s30, 36864
    s_add_u32 s42, s33, 36864
    buffer_load_dwordx4 v[176:179], v238, s[16:19], s41 offen offset:0 sc1
    v_fma_f32 v39, v39, v124, v124
    v_rcp_f32 v32, v32
    v_rcp_f32 v33, v33
    v_rcp_f32 v34, v34
    buffer_load_dwordx4 v[180:183], v239, s[16:19], s42 offen offset:0 sc1
    v_rcp_f32 v35, v35
    v_rcp_f32 v36, v36
    v_rcp_f32 v37, v37
    v_rcp_f32 v38, v38
    v_rcp_f32 v39, v39
    buffer_load_dwordx4 v[184:187], v238, s[16:19], s41 offen offset:2048 sc1
    v_mul_f32 v32, v80, v32
    v_mul_f32 v33, v81, v33
    v_mul_f32 v34, v82, v34
    v_mul_f32 v35, v83, v35
    v_mul_f32 v36, v84, v36
    buffer_load_dwordx4 v[188:191], v239, s[16:19], s42 offen offset:2048 sc1
    v_mul_f32 v37, v85, v37
    v_mul_f32 v38, v86, v38
    v_mul_f32 v39, v87, v39
    v_cvt_pk_bf16_f32 v56, v32, v33
    s_add_u32 s41, s30, 8192
    s_add_u32 s42, s33, 8192
    buffer_load_dwordx4 v[192:195], v238, s[16:19], s41 offen offset:0 sc1
    v_cvt_pk_bf16_f32 v57, v34, v35
    v_cvt_pk_bf16_f32 v58, v36, v37
    v_cvt_pk_bf16_f32 v59, v38, v39
    buffer_store_dwordx4 v[56:59], v127, s[16:19], s61 offen offset:0 sc1
    v_mul_f32 v40, v88, v88
    buffer_load_dwordx4 v[196:199], v239, s[16:19], s42 offen offset:0 sc1
    v_mul_f32 v41, v89, v89
    v_mul_f32 v42, v90, v90
    v_mul_f32 v43, v91, v91
    v_mul_f32 v44, v92, v92
    buffer_load_dwordx4 v[200:203], v238, s[16:19], s41 offen offset:2048 sc1
    v_mul_f32 v45, v93, v93
    v_mul_f32 v46, v94, v94
    v_mul_f32 v47, v95, v95
    v_fma_f32 v40, v40, v30, v31
    v_fma_f32 v41, v41, v30, v31
    buffer_load_dwordx4 v[204:207], v239, s[16:19], s42 offen offset:2048 sc1
    v_fma_f32 v42, v42, v30, v31
    v_fma_f32 v43, v43, v30, v31
    v_fma_f32 v44, v44, v30, v31
    v_fma_f32 v45, v45, v30, v31
    v_fma_f32 v46, v46, v30, v31
    s_add_u32 s41, s30, 12288
    s_add_u32 s42, s33, 12288
    buffer_load_dwordx4 v[208:211], v238, s[16:19], s41 offen offset:0 sc1
    v_fma_f32 v47, v47, v30, v31
    v_mul_f32 v40, v88, v40
    v_mul_f32 v41, v89, v41
    v_mul_f32 v42, v90, v42
    buffer_load_dwordx4 v[212:215], v239, s[16:19], s42 offen offset:0 sc1
    v_mul_f32 v43, v91, v43
    v_mul_f32 v44, v92, v44
    v_mul_f32 v45, v93, v45
    v_mul_f32 v46, v94, v46
    v_mul_f32 v47, v95, v47
    buffer_load_dwordx4 v[216:219], v238, s[16:19], s41 offen offset:2048 sc1
    v_exp_f32 v40, v40
    v_exp_f32 v41, v41
    v_exp_f32 v42, v42
    v_exp_f32 v43, v43
    buffer_load_dwordx4 v[220:223], v239, s[16:19], s42 offen offset:2048 sc1
    v_exp_f32 v44, v44
    v_exp_f32 v45, v45
    v_exp_f32 v46, v46
    v_exp_f32 v47, v47
    v_fma_f32 v40, v40, v124, v124
    s_add_u32 m0, s34, 32768
    s_add_u32 s38, s43, 114688
    buffer_load_dwordx4 v3, s[12:15], s38 offen lds
    v_fma_f32 v41, v41, v124, v124
    v_fma_f32 v42, v42, v124, v124
    v_fma_f32 v43, v43, v124, v124
    v_fma_f32 v44, v44, v124, v124
    v_fma_f32 v45, v45, v124, v124
    s_add_u32 m0, s34, 33792
    s_add_u32 s38, s43, 122880
    buffer_load_dwordx4 v3, s[12:15], s38 offen lds
    v_fma_f32 v46, v46, v124, v124
    v_fma_f32 v47, v47, v124, v124
    v_rcp_f32 v40, v40
    v_rcp_f32 v41, v41
    s_add_u32 m0, s34, 40960
    s_add_u32 s38, s43, 327680
    buffer_load_dwordx4 v3, s[12:15], s38 offen lds
    v_rcp_f32 v42, v42
    v_rcp_f32 v43, v43
    v_rcp_f32 v44, v44
    v_rcp_f32 v45, v45
    v_rcp_f32 v46, v46
    s_add_u32 m0, s34, 41984
    s_add_u32 s38, s43, 335872
    buffer_load_dwordx4 v3, s[12:15], s38 offen lds
    v_rcp_f32 v47, v47
    v_mul_f32 v40, v88, v40
    v_mul_f32 v41, v89, v41
    v_mul_f32 v42, v90, v42
    v_mul_f32 v43, v91, v43
    v_mul_f32 v44, v92, v44
    v_mul_f32 v45, v93, v45
    v_mul_f32 v46, v94, v46
    v_mul_f32 v47, v95, v47
    v_cvt_pk_bf16_f32 v60, v40, v41
    v_cvt_pk_bf16_f32 v61, v42, v43
    v_cvt_pk_bf16_f32 v62, v44, v45
    v_cvt_pk_bf16_f32 v63, v46, v47
    buffer_store_dwordx4 v[60:63], v127, s[16:19], s61 offen offset:2048 sc1
    s_branch K_P2
K_FG:
    s_lshl_b32 s38, s26, 14
    v_subrev_u32 v4, s38, v4
    v_subrev_u32 v5, s38, v5
    v_subrev_u32 v6, s38, v6
    v_subrev_u32 v7, s38, v7
    s_setprio 2
    ds_read_b128 v[48:51], v15
    ds_read_b64_tr_b16 v[96:97], v4 offset:0
    ds_read_b64_tr_b16 v[98:99], v4 offset:256
    ds_read_b64_tr_b16 v[100:101], v5 offset:0
    ds_read_b64_tr_b16 v[102:103], v5 offset:256
    ds_read_b64_tr_b16 v[104:105], v6 offset:0
    ds_read_b64_tr_b16 v[106:107], v6 offset:256
    ds_read_b64_tr_b16 v[108:109], v7 offset:0
    ds_read_b64_tr_b16 v[110:111], v7 offset:256
    ds_read_b64_tr_b16 v[112:113], v4 offset:4096
    ds_read_b64_tr_b16 v[114:115], v4 offset:4352
    s_waitcnt lgkmcnt(8)
    v_mfma_f32_32x32x16_bf16 v[64:79], v[96:99], v[128:131], 0
    v_mfma_f32_16x16x32_bf16 v[20:23], v[16:19], v[96:99], 0
    v_add_f32 v48, v48, v49
    v_add_f32 v50, v50, v51
    v_add_f32 v48, v48, v50
    v_cvt_pk_bf16_f32 v49, v48, v48
    v_and_b32 v49, s37, v49
    v_sub_f32 v49, v48, v49
    v_cvt_pk_bf16_f32 v24, v48, v49
    ds_read_b64_tr_b16 v[96:97], v5 offset:4096
    ds_read_b64_tr_b16 v[98:99], v5 offset:4352
    s_waitcnt lgkmcnt(8)
    v_mfma_f32_32x32x16_bf16 v[64:79], v[100:103], v[132:135], v[64:79]
    v_and_b32 v48, s37, v24
    v_sub_f32 v49, v49, v48
    v_cvt_pk_bf16_f32 v25, v49, v118
    s_nop 1
    v_mfma_f32_32x32x16_bf16 v[80:95], v[24:27], v[26:29], v[80:95]
    ds_read_b64_tr_b16 v[100:101], v6 offset:4096
    ds_read_b64_tr_b16 v[102:103], v6 offset:4352
    s_waitcnt lgkmcnt(8)
    v_mfma_f32_32x32x16_bf16 v[64:79], v[104:107], v[136:139], v[64:79]
    s_nop 7
    v_mul_f32 v32, v80, v80
    v_mul_f32 v33, v81, v81
    v_mul_f32 v34, v82, v82
    ds_read_b64_tr_b16 v[104:105], v7 offset:4096
    ds_read_b64_tr_b16 v[106:107], v7 offset:4352
    s_waitcnt lgkmcnt(8)
    v_mfma_f32_32x32x16_bf16 v[64:79], v[108:111], v[140:143], v[64:79]
    v_mul_f32 v35, v83, v83
    v_mul_f32 v36, v84, v84
    v_mul_f32 v37, v85, v85
    v_mul_f32 v38, v86, v86
    v_mul_f32 v39, v87, v87
    v_fma_f32 v32, v32, v30, v31
    v_fma_f32 v33, v33, v30, v31
    ds_read_b64_tr_b16 v[108:109], v4 offset:8192
    ds_read_b64_tr_b16 v[110:111], v4 offset:8448
    s_waitcnt lgkmcnt(8)
    v_mfma_f32_32x32x16_bf16 v[64:79], v[112:115], v[144:147], v[64:79]
    v_mfma_f32_16x16x32_bf16 v[20:23], v[16:19], v[112:115], v[20:23]
    v_fma_f32 v34, v34, v30, v31
    v_fma_f32 v35, v35, v30, v31
    v_fma_f32 v36, v36, v30, v31
    v_fma_f32 v37, v37, v30, v31
    v_fma_f32 v38, v38, v30, v31
    v_fma_f32 v39, v39, v30, v31
    v_mul_f32 v32, v80, v32
    ds_read_b64_tr_b16 v[112:113], v5 offset:8192
    ds_read_b64_tr_b16 v[114:115], v5 offset:8448
    s_waitcnt lgkmcnt(8)
    v_mfma_f32_32x32x16_bf16 v[64:79], v[96:99], v[148:151], v[64:79]
    v_mul_f32 v33, v81, v33
    v_mul_f32 v34, v82, v34
    v_mul_f32 v35, v83, v35
    v_mul_f32 v36, v84, v36
    v_mul_f32 v37, v85, v37
    v_mul_f32 v38, v86, v38
    v_mul_f32 v39, v87, v39
    ds_read_b64_tr_b16 v[96:97], v6 offset:8192
    ds_read_b64_tr_b16 v[98:99], v6 offset:8448
    s_waitcnt lgkmcnt(8)
    v_mfma_f32_32x32x16_bf16 v[64:79], v[100:103], v[152:155], v[64:79]
    v_exp_f32 v32, v32
    v_exp_f32 v33, v33
    v_exp_f32 v34, v34
    v_exp_f32 v35, v35
    ds_read_b64_tr_b16 v[100:101], v7 offset:8192
    ds_read_b64_tr_b16 v[102:103], v7 offset:8448
    s_waitcnt lgkmcnt(8)
    v_mfma_f32_32x32x16_bf16 v[64:79], v[104:107], v[156:159], v[64:79]
    v_exp_f32 v36, v36
    v_exp_f32 v37, v37
    v_exp_f32 v38, v38
    v_exp_f32 v39, v39
    ds_read_b64_tr_b16 v[104:105], v4 offset:12288
    ds_read_b64_tr_b16 v[106:107], v4 offset:12544
    s_waitcnt lgkmcnt(8)
    v_mfma_f32_32x32x16_bf16 v[64:79], v[108:111], v[160:163], v[64:79]
    v_mfma_f32_16x16x32_bf16 v[20:23], v[16:19], v[108:111], v[20:23]
    v_fma_f32 v32, v32, v124, v124
    v_fma_f32 v33, v33, v124, v124
    v_fma_f32 v34, v34, v124, v124
    v_fma_f32 v35, v35, v124, v124
    v_fma_f32 v36, v36, v124, v124
    v_fma_f32 v37, v37, v124, v124
    ds_read_b64_tr_b16 v[108:109], v5 offset:12288
    ds_read_b64_tr_b16 v[110:111], v5 offset:12544
    s_waitcnt lgkmcnt(8)
    v_mfma_f32_32x32x16_bf16 v[64:79], v[112:115], v[164:167], v[64:79]
    v_fma_f32 v38, v38, v124, v124
    v_fma_f32 v39, v39, v124, v124
    v_rcp_f32 v32, v32
    v_rcp_f32 v33, v33
    v_rcp_f32 v34, v34
    ds_read_b64_tr_b16 v[112:113], v6 offset:12288
    ds_read_b64_tr_b16 v[114:115], v6 offset:12544
    s_waitcnt lgkmcnt(8)
    v_mfma_f32_32x32x16_bf16 v[64:79], v[96:99], v[168:171], v[64:79]
    v_rcp_f32 v35, v35
    v_rcp_f32 v36, v36
    v_rcp_f32 v37, v37
    v_rcp_f32 v38, v38
    ds_read_b64_tr_b16 v[96:97], v7 offset:12288
    ds_read_b64_tr_b16 v[98:99], v7 offset:12544
    s_waitcnt lgkmcnt(8)
    v_mfma_f32_32x32x16_bf16 v[64:79], v[100:103], v[172:175], v[64:79]
    v_rcp_f32 v39, v39
    v_mul_f32 v32, v80, v32
    v_mul_f32 v33, v81, v33
    v_mul_f32 v34, v82, v34
    v_mul_f32 v35, v83, v35
    v_mul_f32 v36, v84, v36
    ds_read_b64_tr_b16 v[100:101], v4 offset:32768
    ds_read_b64_tr_b16 v[102:103], v4 offset:33024
    s_waitcnt lgkmcnt(8)
    v_mfma_f32_32x32x16_bf16 v[64:79], v[104:107], v[176:179], v[64:79]
    v_mfma_f32_16x16x32_bf16 v[20:23], v[16:19], v[104:107], v[20:23]
    v_mul_f32 v37, v85, v37
    v_mul_f32 v38, v86, v38
    v_mul_f32 v39, v87, v39
    v_cvt_pk_bf16_f32 v56, v32, v33
    v_cvt_pk_bf16_f32 v57, v34, v35
    v_cvt_pk_bf16_f32 v58, v36, v37
    v_cvt_pk_bf16_f32 v59, v38, v39
    ds_read_b64_tr_b16 v[104:105], v5 offset:32768
    ds_read_b64_tr_b16 v[106:107], v5 offset:33024
    s_waitcnt lgkmcnt(8)
    v_mfma_f32_32x32x16_bf16 v[64:79], v[108:111], v[180:183], v[64:79]
    buffer_store_dwordx4 v[56:59], v127, s[16:19], s61 offen offset:0 sc1
    v_mul_f32 v40, v88, v88
    v_mul_f32 v41, v89, v89
    v_mul_f32 v42, v90, v90
    v_mul_f32 v43, v91, v91
    v_mul_f32 v44, v92, v92
    ds_read_b64_tr_b16 v[108:109], v6 offset:32768
    ds_read_b64_tr_b16 v[110:111], v6 offset:33024
    s_waitcnt lgkmcnt(8)
    v_mfma_f32_32x32x16_bf16 v[64:79], v[112:115], v[184:187], v[64:79]
    v_mul_f32 v45, v93, v93
    v_mul_f32 v46, v94, v94
    v_mul_f32 v47, v95, v95
    v_fma_f32 v40, v40, v30, v31
    v_fma_f32 v41, v41, v30, v31
    v_fma_f32 v42, v42, v30, v31
    v_fma_f32 v43, v43, v30, v31
    ds_read_b64_tr_b16 v[112:113], v7 offset:32768
    ds_read_b64_tr_b16 v[114:115], v7 offset:33024
    s_waitcnt lgkmcnt(8)
    v_mfma_f32_32x32x16_bf16 v[64:79], v[96:99], v[188:191], v[64:79]
    v_fma_f32 v44, v44, v30, v31
    v_fma_f32 v45, v45, v30, v31
    v_fma_f32 v46, v46, v30, v31
    v_fma_f32 v47, v47, v30, v31
    v_mul_f32 v40, v88, v40
    v_mul_f32 v41, v89, v41
    v_mul_f32 v42, v90, v42
    ds_read_b64_tr_b16 v[96:97], v4 offset:36864
    ds_read_b64_tr_b16 v[98:99], v4 offset:37120
    s_waitcnt lgkmcnt(8)
    v_mfma_f32_32x32x16_bf16 v[64:79], v[100:103], v[192:195], v[64:79]
    v_mfma_f32_16x16x32_bf16 v[20:23], v[16:19], v[100:103], v[20:23]
    v_mul_f32 v43, v91, v43
    v_mul_f32 v44, v92, v44
    v_mul_f32 v45, v93, v45
    v_mul_f32 v46, v94, v46
    v_mul_f32 v47, v95, v47
    v_exp_f32 v40, v40
    ds_read_b64_tr_b16 v[100:101], v5 offset:36864
    ds_read_b64_tr_b16 v[102:103], v5 offset:37120
    s_waitcnt lgkmcnt(8)
    v_mfma_f32_32x32x16_bf16 v[64:79], v[104:107], v[196:199], v[64:79]
    v_exp_f32 v41, v41
    v_exp_f32 v42, v42
    v_exp_f32 v43, v43
    v_exp_f32 v44, v44
    ds_read_b64_tr_b16 v[104:105], v6 offset:36864
    ds_read_b64_tr_b16 v[106:107], v6 offset:37120
    s_waitcnt lgkmcnt(8)
    v_mfma_f32_32x32x16_bf16 v[64:79], v[108:111], v[200:203], v[64:79]
    v_exp_f32 v45, v45
    v_exp_f32 v46, v46
    v_exp_f32 v47, v47
    v_fma_f32 v40, v40, v124, v124
    ds_read_b64_tr_b16 v[108:109], v7 offset:36864
    ds_read_b64_tr_b16 v[110:111], v7 offset:37120
    s_waitcnt lgkmcnt(8)
    v_mfma_f32_32x32x16_bf16 v[64:79], v[112:115], v[204:207], v[64:79]
    v_fma_f32 v41, v41, v124, v124
    v_fma_f32 v42, v42, v124, v124
    v_fma_f32 v43, v43, v124, v124
    v_fma_f32 v44, v44, v124, v124
    v_fma_f32 v45, v45, v124, v124
    v_fma_f32 v46, v46, v124, v124
    v_fma_f32 v47, v47, v124, v124
    ds_read_b64_tr_b16 v[112:113], v4 offset:40960
    ds_read_b64_tr_b16 v[114:115], v4 offset:41216
    s_waitcnt lgkmcnt(8)
    v_mfma_f32_32x32x16_bf16 v[64:79], v[96:99], v[208:211], v[64:79]
    v_mfma_f32_16x16x32_bf16 v[20:23], v[16:19], v[96:99], v[20:23]
    v_rcp_f32 v40, v40
    v_rcp_f32 v41, v41
    v_rcp_f32 v42, v42
    v_rcp_f32 v43, v43
    ds_read_b64_tr_b16 v[96:97], v5 offset:40960
    ds_read_b64_tr_b16 v[98:99], v5 offset:41216
    s_waitcnt lgkmcnt(8)
    v_mfma_f32_32x32x16_bf16 v[64:79], v[100:103], v[212:215], v[64:79]
    v_rcp_f32 v44, v44
    v_rcp_f32 v45, v45
    v_rcp_f32 v46, v46
    v_rcp_f32 v47, v47
    ds_read_b64_tr_b16 v[100:101], v6 offset:40960
    ds_read_b64_tr_b16 v[102:103], v6 offset:41216
    s_waitcnt lgkmcnt(8)
    v_mfma_f32_32x32x16_bf16 v[64:79], v[104:107], v[216:219], v[64:79]
    v_mul_f32 v40, v88, v40
    v_mul_f32 v41, v89, v41
    v_mul_f32 v42, v90, v42
    v_mul_f32 v43, v91, v43
    v_mul_f32 v44, v92, v44
    v_mul_f32 v45, v93, v45
    v_mul_f32 v46, v94, v46
    ds_read_b64_tr_b16 v[104:105], v7 offset:40960
    ds_read_b64_tr_b16 v[106:107], v7 offset:41216
    s_waitcnt lgkmcnt(8)
    v_mfma_f32_32x32x16_bf16 v[64:79], v[108:111], v[220:223], v[64:79]
    v_mul_f32 v47, v95, v47
    v_cvt_pk_bf16_f32 v60, v40, v41
    v_cvt_pk_bf16_f32 v61, v42, v43
    v_cvt_pk_bf16_f32 v62, v44, v45
    v_cvt_pk_bf16_f32 v63, v46, v47
    buffer_store_dwordx4 v[60:63], v127, s[16:19], s61 offen offset:2048 sc1
    ds_read_b64_tr_b16 v[108:109], v4 offset:45056
    ds_read_b64_tr_b16 v[110:111], v4 offset:45312
    s_waitcnt lgkmcnt(8)
    v_mfma_f32_32x32x16_bf16 v[64:79], v[112:115], v[224:227], v[64:79]
    v_mfma_f32_16x16x32_bf16 v[20:23], v[16:19], v[112:115], v[20:23]
    ds_read_b64_tr_b16 v[112:113], v5 offset:45056
    ds_read_b64_tr_b16 v[114:115], v5 offset:45312
    s_waitcnt lgkmcnt(8)
    v_mfma_f32_32x32x16_bf16 v[64:79], v[96:99], v[228:231], v[64:79]
    ds_read_b64_tr_b16 v[96:97], v6 offset:45056
    ds_read_b64_tr_b16 v[98:99], v6 offset:45312
    s_waitcnt lgkmcnt(8)
    v_mfma_f32_32x32x16_bf16 v[64:79], v[100:103], v[232:235], v[64:79]
    ds_read_b64_tr_b16 v[100:101], v7 offset:45056
    ds_read_b64_tr_b16 v[102:103], v7 offset:45312
    s_waitcnt lgkmcnt(8)
    v_mfma_f32_32x32x16_bf16 v[64:79], v[104:107], v[236:239], v[64:79]
    s_waitcnt lgkmcnt(6)
    v_mfma_f32_32x32x16_bf16 v[64:79], v[108:111], v[240:243], v[64:79]
    v_mfma_f32_16x16x32_bf16 v[20:23], v[16:19], v[108:111], v[20:23]
    s_waitcnt lgkmcnt(4)
    v_mfma_f32_32x32x16_bf16 v[64:79], v[112:115], v[244:247], v[64:79]
    s_waitcnt lgkmcnt(2)
    v_mfma_f32_32x32x16_bf16 v[64:79], v[96:99], v[248:251], v[64:79]
    s_waitcnt lgkmcnt(0)
    v_mfma_f32_32x32x16_bf16 v[80:95], v[100:103], v[252:255], v[64:79]
    v_xor_b32 v15, 1024, v15
    s_lshl_b32 s61, s47, 6
    s_add_u32 s61, s61, s50
    ds_write_b32 v14, v20
    v_mov_b32 v8, 0x21400
    v_mov_b32 v9, 1
    s_waitcnt lgkmcnt(0)
    s_mov_b64 exec, 1
    ds_add_u32 v8, v9
    s_mov_b64 exec, -1
K_FSP:
    ds_read_b32 v9, v8
    s_waitcnt lgkmcnt(0)
    v_readfirstlane_b32 s38, v9
    s_nop 3
    s_cmp_lt_u32 s38, 4
    s_cbranch_scc1 K_FSP
    ds_read_b128 v[48:51], v15
    s_waitcnt lgkmcnt(0)
    v_add_f32 v48, v48, v49
    v_add_f32 v50, v50, v51
    v_add_f32 v48, v48, v50
    v_cvt_pk_bf16_f32 v49, v48, v48
    v_and_b32 v49, s37, v49
    v_sub_f32 v49, v48, v49
    v_cvt_pk_bf16_f32 v24, v48, v49
    v_and_b32 v48, s37, v24
    v_sub_f32 v49, v49, v48
    v_cvt_pk_bf16_f32 v25, v49, v119
    s_nop 1
    v_mfma_f32_32x32x16_bf16 v[80:95], v[24:27], v[26:29], v[80:95]
    s_nop 11
    v_mul_f32 v32, v80, v80
    v_mul_f32 v33, v81, v81
    v_mul_f32 v34, v82, v82
    v_mul_f32 v35, v83, v83
    v_mul_f32 v36, v84, v84
    v_mul_f32 v37, v85, v85
    v_mul_f32 v38, v86, v86
    v_mul_f32 v39, v87, v87
    v_fma_f32 v32, v32, v30, v31
    v_fma_f32 v33, v33, v30, v31
    v_fma_f32 v34, v34, v30, v31
    v_fma_f32 v35, v35, v30, v31
    v_fma_f32 v36, v36, v30, v31
    v_fma_f32 v37, v37, v30, v31
    v_fma_f32 v38, v38, v30, v31
    v_fma_f32 v39, v39, v30, v31
    v_mul_f32 v32, v80, v32
    v_mul_f32 v33, v81, v33
    v_mul_f32 v34, v82, v34
    v_mul_f32 v35, v83, v35
    v_mul_f32 v36, v84, v36
    v_mul_f32 v37, v85, v37
    v_mul_f32 v38, v86, v38
    v_mul_f32 v39, v87, v39
    v_exp_f32 v32, v32
    v_exp_f32 v33, v33
    v_exp_f32 v34, v34
    v_exp_f32 v35, v35
    v_exp_f32 v36, v36
    v_exp_f32 v37, v37
    v_exp_f32 v38, v38
    v_exp_f32 v39, v39
    v_fma_f32 v32, v32, v124, v124
    v_fma_f32 v33, v33, v124, v124
    v_fma_f32 v34, v34, v124, v124
    v_fma_f32 v35, v35, v124, v124
    v_fma_f32 v36, v36, v124, v124
    v_fma_f32 v37, v37, v124, v124
    v_fma_f32 v38, v38, v124, v124
    v_fma_f32 v39, v39, v124, v124
    v_rcp_f32 v32, v32
    v_rcp_f32 v33, v33
    v_rcp_f32 v34, v34
    v_rcp_f32 v35, v35
    v_rcp_f32 v36, v36
    v_rcp_f32 v37, v37
    v_rcp_f32 v38, v38
    v_rcp_f32 v39, v39
    v_mul_f32 v32, v80, v32
    v_mul_f32 v33, v81, v33
    v_mul_f32 v34, v82, v34
    v_mul_f32 v35, v83, v35
    v_mul_f32 v36, v84, v36
    v_mul_f32 v37, v85, v37
    v_mul_f32 v38, v86, v38
    v_mul_f32 v39, v87, v39
    v_cvt_pk_bf16_f32 v56, v32, v33
    v_cvt_pk_bf16_f32 v57, v34, v35
    v_cvt_pk_bf16_f32 v58, v36, v37
    v_cvt_pk_bf16_f32 v59, v38, v39
    buffer_store_dwordx4 v[56:59], v127, s[16:19], s61 offen offset:0 sc1
    v_mul_f32 v40, v88, v88
    v_mul_f32 v41, v89, v89
    v_mul_f32 v42, v90, v90
    v_mul_f32 v43, v91, v91
    v_mul_f32 v44, v92, v92
    v_mul_f32 v45, v93, v93
    v_mul_f32 v46, v94, v94
    v_mul_f32 v47, v95, v95
    v_fma_f32 v40, v40, v30, v31
    v_fma_f32 v41, v41, v30, v31
    v_fma_f32 v42, v42, v30, v31
    v_fma_f32 v43, v43, v30, v31
    v_fma_f32 v44, v44, v30, v31
    v_fma_f32 v45, v45, v30, v31
    v_fma_f32 v46, v46, v30, v31
    v_fma_f32 v47, v47, v30, v31
    v_mul_f32 v40, v88, v40
    v_mul_f32 v41, v89, v41
    v_mul_f32 v42, v90, v42
    v_mul_f32 v43, v91, v43
    v_mul_f32 v44, v92, v44
    v_mul_f32 v45, v93, v45
    v_mul_f32 v46, v94, v46
    v_mul_f32 v47, v95, v47
    v_exp_f32 v40, v40
    v_exp_f32 v41, v41
    v_exp_f32 v42, v42
    v_exp_f32 v43, v43
    v_exp_f32 v44, v44
    v_exp_f32 v45, v45
    v_exp_f32 v46, v46
    v_exp_f32 v47, v47
    v_fma_f32 v40, v40, v124, v124
    v_fma_f32 v41, v41, v124, v124
    v_fma_f32 v42, v42, v124, v124
    v_fma_f32 v43, v43, v124, v124
    v_fma_f32 v44, v44, v124, v124
    v_fma_f32 v45, v45, v124, v124
    v_fma_f32 v46, v46, v124, v124
    v_fma_f32 v47, v47, v124, v124
    v_rcp_f32 v40, v40
    v_rcp_f32 v41, v41
    v_rcp_f32 v42, v42
    v_rcp_f32 v43, v43
    v_rcp_f32 v44, v44
    v_rcp_f32 v45, v45
    v_rcp_f32 v46, v46
    v_rcp_f32 v47, v47
    v_mul_f32 v40, v88, v40
    v_mul_f32 v41, v89, v41
    v_mul_f32 v42, v90, v42
    v_mul_f32 v43, v91, v43
    v_mul_f32 v44, v92, v44
    v_mul_f32 v45, v93, v45
    v_mul_f32 v46, v94, v46
    v_mul_f32 v47, v95, v47
    v_cvt_pk_bf16_f32 v60, v40, v41
    v_cvt_pk_bf16_f32 v61, v42, v43
    v_cvt_pk_bf16_f32 v62, v44, v45
    v_cvt_pk_bf16_f32 v63, v46, v47
    buffer_store_dwordx4 v[60:63], v127, s[16:19], s61 offen offset:2048 sc1
    s_setprio 0
    s_mov_b32 s20, s98
    s_mov_b32 s21, s99
    s_mov_b32 s22, 0x80000
    s_mov_b32 s23, 0x00020000
    s_lshr_b32 s38, s32, 3
    s_and_b32 s39, s32, 3
    s_lshl_b32 s39, s39, 2
    s_add_u32 s39, s39, s25
    s_lshl_b32 s39, s39, 10
    s_add_u32 s39, s39, 384
    s_mul_i32 s40, s38, 458752
    s_add_u32 s40, s40, s39
    s_lshl_b32 s41, s38, 17
    s_add_u32 s41, s41, s39
    s_buffer_load_dword s42, s[64:67], s40 offset:131072
    s_buffer_load_dword s42, s[64:67], s40 offset:131136
    s_buffer_load_dword s42, s[64:67], s40 offset:147456
    s_buffer_load_dword s42, s[64:67], s40 offset:147520
    s_buffer_load_dword s42, s[64:67], s40 offset:163840
    s_buffer_load_dword s42, s[64:67], s40 offset:163904
    s_buffer_load_dword s42, s[64:67], s40 offset:180224
    s_buffer_load_dword s42, s[64:67], s40 offset:180288
    s_buffer_load_dword s42, s[64:67], s40 offset:393216
    s_buffer_load_dword s42, s[64:67], s40 offset:393280
    s_buffer_load_dword s42, s[64:67], s40 offset:409600
    s_buffer_load_dword s42, s[64:67], s40 offset:409664
    s_waitcnt lgkmcnt(0)
    s_buffer_load_dword s42, s[64:67], s40 offset:425984
    s_buffer_load_dword s42, s[64:67], s40 offset:426048
    s_buffer_load_dword s42, s[64:67], s40 offset:442368
    s_buffer_load_dword s42, s[64:67], s40 offset:442432
    s_buffer_load_dword s42, s[64:67], s40 offset:196608
    s_buffer_load_dword s42, s[64:67], s40 offset:196672
    s_buffer_load_dword s42, s[64:67], s40 offset:212992
    s_buffer_load_dword s42, s[64:67], s40 offset:213056
    s_buffer_load_dword s42, s[64:67], s40 offset:229376
    s_buffer_load_dword s42, s[64:67], s40 offset:229440
    s_buffer_load_dword s42, s[64:67], s40 offset:245760
    s_buffer_load_dword s42, s[64:67], s40 offset:245824
    s_waitcnt lgkmcnt(0)
    s_buffer_load_dword s42, s[20:23], s41 offset:0
    s_buffer_load_dword s42, s[20:23], s41 offset:64
    s_buffer_load_dword s42, s[20:23], s41 offset:16384
    s_buffer_load_dword s42, s[20:23], s41 offset:16448
    s_buffer_load_dword s42, s[20:23], s41 offset:32768
    s_buffer_load_dword s42, s[20:23], s41 offset:32832
    s_buffer_load_dword s42, s[20:23], s41 offset:49152
    s_buffer_load_dword s42, s[20:23], s41 offset:49216
    s_buffer_load_dword s42, s[20:23], s41 offset:65536
    s_buffer_load_dword s42, s[20:23], s41 offset:65600
    s_buffer_load_dword s42, s[20:23], s41 offset:81920
    s_buffer_load_dword s42, s[20:23], s41 offset:81984
    s_waitcnt lgkmcnt(0)
    s_buffer_load_dword s42, s[20:23], s41 offset:98304
    s_buffer_load_dword s42, s[20:23], s41 offset:98368
    s_buffer_load_dword s42, s[20:23], s41 offset:114688
    s_buffer_load_dword s42, s[20:23], s41 offset:114752
    s_waitcnt lgkmcnt(0)
    s_branch K_GFIN
K_QKV:
    v_lshrrev_b32 v31, 5, v1
    v_lshl_add_u32 v31, v31, 4, s61
    s_waitcnt vmcnt(0)
    ds_read_b64_tr_b16 v[118:119], v116 offset:256
    ds_read_b64_tr_b16 v[116:117], v116
    s_waitcnt lgkmcnt(0)
    s_barrier
    s_add_u32 s53, s56, s46
    s_mov_b32 s55, s42
    ds_read_b128 v[48:51], v15
    ds_read_b64 v[8:9], v32
    ds_read_b64_tr_b16 v[96:97], v4 offset:0
    ds_read_b64_tr_b16 v[98:99], v4 offset:256
    ds_read_b64_tr_b16 v[100:101], v5 offset:0
    ds_read_b64_tr_b16 v[102:103], v5 offset:256
    ds_read_b64_tr_b16 v[104:105], v6 offset:0
    ds_read_b64_tr_b16 v[106:107], v6 offset:256
    ds_read_b64_tr_b16 v[108:109], v7 offset:0
    ds_read_b64_tr_b16 v[110:111], v7 offset:256
    ds_read_b64_tr_b16 v[112:113], v4 offset:4096
    ds_read_b64_tr_b16 v[114:115], v4 offset:4352
    s_waitcnt lgkmcnt(8)
    v_mfma_f32_32x32x16_bf16 v[64:79], v[128:131], v[96:99], 0
    v_mfma_f32_16x16x32_bf16 v[20:23], v[16:19], v[96:99], 0
    s_mov_b32 m0, s55
    s_add_u32 s54, s53, 64
    buffer_load_dwordx4 v3, s[12:15], s53 offen lds
    v_add_f32 v8, v8, v44
    v_add_f32 v9, v9, v45
    v_mul_f32 v8, 0xbb000000, v8
    v_mul_f32 v9, 0x3b000000, v9
    v_fma_f32 v9, -v8, v8, v9
    v_cvt_pk_bf16_f32 v26, v8, v8
    v_max_f32 v9, 0, v9
    v_cvt_pk_bf16_f32 v9, v9, v9
    ds_read_b64_tr_b16 v[96:97], v5 offset:4096
    ds_read_b64_tr_b16 v[98:99], v5 offset:4352
    s_waitcnt lgkmcnt(8)
    v_mfma_f32_32x32x16_bf16 v[64:79], v[132:135], v[100:103], v[64:79]
    v_and_b32 v9, s37, v9
    v_add_f32 v9, 0x3727c5ac, v9
    v_cvt_pk_bf16_f32 v9, v9, v9
    s_add_u32 m0, s55, 0x4000
    s_add_u32 s53, s53, s52
    buffer_load_dwordx4 v3, s[12:15], s54 offen lds
    s_add_u32 s55, s55, 1024
    v_and_b32 v9, s37, v9
    v_sqrt_f32 v9, v9
    v_cndmask_b32 v26, 0, v26, vcc
    v_cvt_pk_bf16_f32 v27, v8, v9
    v_and_b32 v9, s37, v27
    ds_read_b64_tr_b16 v[100:101], v6 offset:4096
    ds_read_b64_tr_b16 v[102:103], v6 offset:4352
    s_waitcnt lgkmcnt(8)
    v_mfma_f32_32x32x16_bf16 v[64:79], v[136:139], v[104:107], v[64:79]
    v_rcp_f32 v8, v9
    v_cndmask_b32 v27, 0, v27, vcc
    v_mul_f32 v30, 0x3fb8aa3b, v8
    v_add_u32 v9, s61, v34
    ds_write_b32 v9, v8
    v_add_f32 v48, v48, v49
    s_mov_b32 m0, s55
    s_add_u32 s54, s53, 64
    buffer_load_dwordx4 v3, s[12:15], s53 offen lds
    v_add_f32 v50, v50, v51
    ds_read_b64_tr_b16 v[104:105], v7 offset:4096
    ds_read_b64_tr_b16 v[106:107], v7 offset:4352
    s_waitcnt lgkmcnt(8)
    v_mfma_f32_32x32x16_bf16 v[64:79], v[140:143], v[108:111], v[64:79]
    v_add_f32 v48, v48, v50
    v_cvt_pk_bf16_f32 v49, v48, v48
    v_and_b32 v49, s37, v49
    v_sub_f32 v49, v48, v49
    v_cvt_pk_bf16_f32 v24, v48, v49
    v_and_b32 v48, s37, v24
    v_sub_f32 v49, v49, v48
    v_cvt_pk_bf16_f32 v25, v49, 0
    s_nop 1
    v_mfma_f32_32x32x16_bf16 v[80:95], v[24:27], v[26:29], v[80:95]
    ds_read_b64_tr_b16 v[108:109], v4 offset:8192
    ds_read_b64_tr_b16 v[110:111], v4 offset:8448
    s_waitcnt lgkmcnt(8)
    v_mfma_f32_32x32x16_bf16 v[64:79], v[144:147], v[112:115], v[64:79]
    v_mfma_f32_16x16x32_bf16 v[20:23], v[16:19], v[112:115], v[20:23]
    s_add_u32 m0, s55, 0x4000
    s_add_u32 s53, s53, s76
    buffer_load_dwordx4 v3, s[12:15], s54 offen lds
    s_add_u32 s55, s55, 0x7c00
    s_nop 11
    v_cvt_pk_bf16_f32 v48, v80, v81
    v_cvt_pk_bf16_f32 v49, v82, v83
    v_cvt_pk_bf16_f32 v50, v84, v85
    ds_read_b64_tr_b16 v[112:113], v5 offset:8192
    ds_read_b64_tr_b16 v[114:115], v5 offset:8448
    s_waitcnt lgkmcnt(8)
    v_mfma_f32_32x32x16_bf16 v[64:79], v[148:151], v[96:99], v[64:79]
    v_cvt_pk_bf16_f32 v51, v86, v87
    v_cvt_pk_bf16_f32 v52, v88, v89
    v_cvt_pk_bf16_f32 v53, v90, v91
    s_mov_b32 m0, s55
    s_add_u32 s54, s53, 64
    buffer_load_dwordx4 v3, s[12:15], s53 offen lds
    v_cvt_pk_bf16_f32 v54, v92, v93
    v_cvt_pk_bf16_f32 v55, v94, v95
    s_nop 1
    v_mfma_f32_32x32x16_bf16 v[32:47], v[116:119], v[52:55], 0
    v_mfma_f32_32x32x16_bf16 v[80:95], v[116:119], v[48:51], 0
    ds_read_b64_tr_b16 v[96:97], v6 offset:8192
    ds_read_b64_tr_b16 v[98:99], v6 offset:8448
    s_waitcnt lgkmcnt(8)
    v_mfma_f32_32x32x16_bf16 v[64:79], v[152:155], v[100:103], v[64:79]
    s_nop 10
    v_max3_f32 v8, v40, v41, v42
    v_max3_f32 v9, -v40, -v41, -v42
    v_max3_f32 v8, v8, v43, v44
    s_add_u32 m0, s55, 0x4000
    s_add_u32 s53, s53, s52
    buffer_load_dwordx4 v3, s[12:15], s54 offen lds
    s_add_u32 s55, s55, 1024
    ds_read_b64_tr_b16 v[100:101], v7 offset:8192
    ds_read_b64_tr_b16 v[102:103], v7 offset:8448
    s_waitcnt lgkmcnt(8)
    v_mfma_f32_32x32x16_bf16 v[64:79], v[156:159], v[104:107], v[64:79]
    v_max3_f32 v9, v9, -v43, -v44
    v_max3_f32 v8, v8, v45, v46
    v_max3_f32 v9, v9, -v45, -v46
    v_max_f32 v8, v8, v47
    v_max_f32_e64 v9, v9, -v47
    s_nop 1
    v_permlane32_swap_b32 v8, v9
    v_max_f32 v8, v8, v9
    v_mul_f32_e64 v8, -v8, v30
    s_mov_b32 m0, s55
    s_add_u32 s54, s53, 64
    buffer_load_dwordx4 v3, s[12:15], s53 offen lds
    ds_read_b64_tr_b16 v[104:105], v4 offset:12288
    ds_read_b64_tr_b16 v[106:107], v4 offset:12544
    s_waitcnt lgkmcnt(8)
    v_mfma_f32_32x32x16_bf16 v[64:79], v[160:163], v[108:111], v[64:79]
    v_mfma_f32_16x16x32_bf16 v[20:23], v[16:19], v[108:111], v[20:23]
    v_mov_b32 v9, v8
    s_nop 1
    v_permlane32_swap_b32 v8, v9
    v_fma_f32 v32, v40, v30, v8
    v_fma_f32 v33, v41, v30, v8
    v_fma_f32 v34, v42, v30, v8
    v_fma_f32 v35, v43, v30, v8
    v_fma_f32 v36, v44, v30, v8
    v_fma_f32 v37, v45, v30, v8
    v_fma_f32 v38, v46, v30, v8
    ds_read_b64_tr_b16 v[108:109], v5 offset:12288
    ds_read_b64_tr_b16 v[110:111], v5 offset:12544
    s_waitcnt lgkmcnt(8)
    v_mfma_f32_32x32x16_bf16 v[64:79], v[164:167], v[112:115], v[64:79]
    s_add_u32 m0, s55, 0x4000
    s_add_u32 s53, s53, s52
    buffer_load_dwordx4 v3, s[12:15], s54 offen lds
    s_add_u32 s55, s55, 1024
    v_fma_f32 v39, v47, v30, v8
    v_fma_f32 v40, -v40, v30, v9
    v_fma_f32 v41, -v41, v30, v9
    v_fma_f32 v42, -v42, v30, v9
    v_fma_f32 v43, -v43, v30, v9
    v_fma_f32 v44, -v44, v30, v9
    v_fma_f32 v45, -v45, v30, v9
    v_fma_f32 v46, -v46, v30, v9
    v_fma_f32 v47, -v47, v30, v9
    ds_read_b64_tr_b16 v[112:113], v6 offset:12288
    ds_read_b64_tr_b16 v[114:115], v6 offset:12544
    s_waitcnt lgkmcnt(8)
    v_mfma_f32_32x32x16_bf16 v[64:79], v[168:171], v[96:99], v[64:79]
    v_exp_f32 v32, v32
    v_exp_f32 v33, v33
    s_cmp_ge_u32 s24, 4
    s_cbranch_scc1 K_NT
    s_lshl_b32 s40, s28, 3
    s_add_u32 s40, s40, s27
    s_lshl_b32 s40, s40, 1
    s_and_b32 s38, s24, 1
    s_add_u32 s40, s40, s38
    s_cmp_lt_u32 s24, 2
    s_cselect_b64 s[20:21], s[96:97], s[98:99]
    s_mov_b32 s38, 1835008
    s_cselect_b32 s22, s38, 524288
    s_movk_i32 s38, 7168
    s_cselect_b32 s38, s38, 2048
    s_cselect_b32 s39, 56, 16
    s_mul_i32 s38, s38, s40
    v_lshlrev_b32 v0, 7, v1
    s_bfm_b64 exec, s39, 0
    buffer_load_dword v0, v0, s[20:23], s38 offen
    s_mov_b64 exec, -1
K_NT:
    v_exp_f32 v34, v34
    v_exp_f32 v35, v35
    ds_read_b64_tr_b16 v[96:97], v7 offset:12288
    ds_read_b64_tr_b16 v[98:99], v7 offset:12544
    s_waitcnt lgkmcnt(8)
    v_mfma_f32_32x32x16_bf16 v[64:79], v[172:175], v[100:103], v[64:79]
    v_exp_f32 v36, v36
    v_exp_f32 v37, v37
    v_exp_f32 v38, v38
    v_exp_f32 v39, v39
    v_exp_f32 v40, v40
    v_exp_f32 v41, v41
    ds_read_b64_tr_b16 v[100:101], v4 offset:32768
    ds_read_b64_tr_b16 v[102:103], v4 offset:33024
    s_waitcnt lgkmcnt(8)
    v_mfma_f32_32x32x16_bf16 v[64:79], v[176:179], v[104:107], v[64:79]
    v_mfma_f32_16x16x32_bf16 v[20:23], v[16:19], v[104:107], v[20:23]
    v_exp_f32 v42, v42
    v_exp_f32 v43, v43
    v_exp_f32 v44, v44
    v_exp_f32 v45, v45
    v_exp_f32 v46, v46
    v_exp_f32 v47, v47
    ds_read_b64_tr_b16 v[104:105], v5 offset:32768
    ds_read_b64_tr_b16 v[106:107], v5 offset:33024
    s_waitcnt lgkmcnt(8)
    v_mfma_f32_32x32x16_bf16 v[64:79], v[180:183], v[108:111], v[64:79]
    v_add_f32 v10, v32, v33
    v_add_f32 v11, v40, v41
    v_add_f32 v12, v34, v35
    v_add_f32 v13, v42, v43
    v_add_f32 v10, v10, v36
    v_add_f32 v11, v11, v44
    v_add_f32 v12, v12, v37
    v_add_f32 v13, v13, v45
    v_add_f32 v10, v10, v38
    v_add_f32 v11, v11, v46
    v_add_f32 v12, v12, v39
    ds_read_b64_tr_b16 v[108:109], v6 offset:32768
    ds_read_b64_tr_b16 v[110:111], v6 offset:33024
    s_waitcnt lgkmcnt(8)
    v_mfma_f32_32x32x16_bf16 v[64:79], v[184:187], v[112:115], v[64:79]
    v_add_f32 v13, v13, v47
    v_add_f32 v10, v10, v12
    v_add_f32 v11, v11, v13
    s_nop 1
    v_permlane32_swap_b32 v10, v11
    v_add_f32 v10, v10, v11
    v_rcp_f32 v10, v10
    s_nop 0
    v_mov_b32 v11, v10
    s_nop 1
    v_permlane32_swap_b32 v10, v11
    v_mul_f32 v32, v32, v10
    ds_read_b64_tr_b16 v[112:113], v7 offset:32768
    ds_read_b64_tr_b16 v[114:115], v7 offset:33024
    s_waitcnt lgkmcnt(8)
    v_mfma_f32_32x32x16_bf16 v[64:79], v[188:191], v[96:99], v[64:79]
    v_mul_f32 v33, v33, v10
    v_mul_f32 v34, v34, v10
    v_mul_f32 v35, v35, v10
    v_mul_f32 v36, v36, v10
    v_mul_f32 v37, v37, v10
    v_mul_f32 v38, v38, v10
    v_mul_f32 v39, v39, v10
    v_mul_f32 v40, v40, v11
    v_mul_f32 v41, v41, v11
    v_mul_f32 v42, v42, v11
    v_mul_f32 v43, v43, v11
    ds_read_b64_tr_b16 v[96:97], v4 offset:36864
    ds_read_b64_tr_b16 v[98:99], v4 offset:37120
    s_waitcnt lgkmcnt(8)
    v_mfma_f32_32x32x16_bf16 v[64:79], v[192:195], v[100:103], v[64:79]
    v_mfma_f32_16x16x32_bf16 v[20:23], v[16:19], v[100:103], v[20:23]
    v_mul_f32 v44, v44, v11
    v_mul_f32 v45, v45, v11
    v_mul_f32 v46, v46, v11
    v_mul_f32 v47, v47, v11
    v_cvt_pk_bf16_f32 v56, v32, v33
    v_cvt_pk_bf16_f32 v57, v34, v35
    v_cvt_pk_bf16_f32 v58, v36, v37
    v_cvt_pk_bf16_f32 v59, v38, v39
    v_cvt_pk_bf16_f32 v60, v40, v41
    v_cvt_pk_bf16_f32 v61, v42, v43
    v_cvt_pk_bf16_f32 v62, v44, v45
    ds_read_b64_tr_b16 v[100:101], v5 offset:36864
    ds_read_b64_tr_b16 v[102:103], v5 offset:37120
    s_waitcnt lgkmcnt(8)
    v_mfma_f32_32x32x16_bf16 v[64:79], v[196:199], v[104:107], v[64:79]
    v_cvt_pk_bf16_f32 v63, v46, v47
    v_max3_f32 v8, v80, v81, v82
    v_max3_f32 v9, -v80, -v81, -v82
    v_max3_f32 v8, v8, v83, v84
    v_max3_f32 v9, v9, -v83, -v84
    v_max3_f32 v8, v8, v85, v86
    v_max3_f32 v9, v9, -v85, -v86
    v_max_f32 v8, v8, v87
    v_max_f32_e64 v9, v9, -v87
    s_nop 1
    v_permlane32_swap_b32 v8, v9
    ds_read_b64_tr_b16 v[104:105], v6 offset:36864
    ds_read_b64_tr_b16 v[106:107], v6 offset:37120
    s_waitcnt lgkmcnt(8)
    v_mfma_f32_32x32x16_bf16 v[64:79], v[200:203], v[108:111], v[64:79]
    v_max_f32 v8, v8, v9
    v_mul_f32_e64 v8, -v8, v30
    v_mov_b32 v9, v8
    s_nop 1
    v_permlane32_swap_b32 v8, v9
    v_fma_f32 v88, v80, v30, v8
    v_fma_f32 v89, v81, v30, v8
    v_fma_f32 v90, v82, v30, v8
    v_fma_f32 v91, v83, v30, v8
    v_fma_f32 v92, v84, v30, v8
    v_fma_f32 v93, v85, v30, v8
    v_fma_f32 v94, v86, v30, v8
    ds_read_b64_tr_b16 v[108:109], v7 offset:36864
    ds_read_b64_tr_b16 v[110:111], v7 offset:37120
    s_waitcnt lgkmcnt(8)
    v_mfma_f32_32x32x16_bf16 v[64:79], v[204:207], v[112:115], v[64:79]
    v_fma_f32 v95, v87, v30, v8
    v_fma_f32 v80, -v80, v30, v9
    v_fma_f32 v81, -v81, v30, v9
    v_fma_f32 v82, -v82, v30, v9
    v_fma_f32 v83, -v83, v30, v9
    v_fma_f32 v84, -v84, v30, v9
    v_fma_f32 v85, -v85, v30, v9
    v_fma_f32 v86, -v86, v30, v9
    v_fma_f32 v87, -v87, v30, v9
    v_exp_f32 v88, v88
    ds_read_b64_tr_b16 v[112:113], v4 offset:40960
    ds_read_b64_tr_b16 v[114:115], v4 offset:41216
    s_waitcnt lgkmcnt(8)
    v_mfma_f32_32x32x16_bf16 v[64:79], v[208:211], v[96:99], v[64:79]
    v_mfma_f32_16x16x32_bf16 v[20:23], v[16:19], v[96:99], v[20:23]
    v_exp_f32 v89, v89
    v_exp_f32 v90, v90
    v_exp_f32 v91, v91
    v_exp_f32 v92, v92
    v_exp_f32 v93, v93
    v_exp_f32 v94, v94
    ds_read_b64_tr_b16 v[96:97], v5 offset:40960
    ds_read_b64_tr_b16 v[98:99], v5 offset:41216
    s_waitcnt lgkmcnt(8)
    v_mfma_f32_32x32x16_bf16 v[64:79], v[212:215], v[100:103], v[64:79]
    v_exp_f32 v95, v95
    v_exp_f32 v80, v80
    s_cmp_lg_u32 s24, 7
    s_cbranch_scc1 K_QAP
    v_lshlrev_b32 v0, 7, v1
    s_mov_b64 exec, 3
    buffer_load_dword v3, v0, s[4:7], 0 offen sc1
    s_mov_b64 exec, -1
K_QAP:
    v_exp_f32 v81, v81
    v_exp_f32 v82, v82
    v_exp_f32 v83, v83
    ds_read_b64_tr_b16 v[100:101], v6 offset:40960
    ds_read_b64_tr_b16 v[102:103], v6 offset:41216
    s_waitcnt lgkmcnt(8)
    v_mfma_f32_32x32x16_bf16 v[64:79], v[216:219], v[104:107], v[64:79]
    v_exp_f32 v84, v84
    v_exp_f32 v85, v85
    v_exp_f32 v86, v86
    v_exp_f32 v87, v87
    v_add_f32 v10, v88, v89
    v_add_f32 v11, v80, v81
    v_add_f32 v12, v90, v91
    ds_read_b64_tr_b16 v[104:105], v7 offset:40960
    ds_read_b64_tr_b16 v[106:107], v7 offset:41216
    s_waitcnt lgkmcnt(8)
    v_mfma_f32_32x32x16_bf16 v[64:79], v[220:223], v[108:111], v[64:79]
    v_add_f32 v13, v82, v83
    v_add_f32 v10, v10, v92
    v_add_f32 v11, v11, v84
    v_add_f32 v12, v12, v93
    v_add_f32 v13, v13, v85
    v_add_f32 v10, v10, v94
    v_add_f32 v11, v11, v86
    v_add_f32 v12, v12, v95
    v_add_f32 v13, v13, v87
    v_add_f32 v10, v10, v12
    ds_read_b64_tr_b16 v[108:109], v4 offset:45056
    ds_read_b64_tr_b16 v[110:111], v4 offset:45312
    s_waitcnt lgkmcnt(8)
    v_mfma_f32_32x32x16_bf16 v[64:79], v[224:227], v[112:115], v[64:79]
    v_mfma_f32_16x16x32_bf16 v[20:23], v[16:19], v[112:115], v[20:23]
    v_add_f32 v11, v11, v13
    s_nop 1
    v_permlane32_swap_b32 v10, v11
    v_add_f32 v10, v10, v11
    v_rcp_f32 v10, v10
    s_nop 0
    v_mov_b32 v11, v10
    s_nop 1
    v_permlane32_swap_b32 v10, v11
    v_mul_f32 v88, v88, v10
    v_mul_f32 v89, v89, v10
    v_mul_f32 v90, v90, v10
    v_mul_f32 v91, v91, v10
    ds_read_b64_tr_b16 v[112:113], v5 offset:45056
    ds_read_b64_tr_b16 v[114:115], v5 offset:45312
    s_waitcnt lgkmcnt(8)
    v_mfma_f32_32x32x16_bf16 v[64:79], v[228:231], v[96:99], v[64:79]
    v_mul_f32 v92, v92, v10
    v_mul_f32 v93, v93, v10
    v_mul_f32 v94, v94, v10
    v_mul_f32 v95, v95, v10
    v_mul_f32 v80, v80, v11
    v_mul_f32 v81, v81, v11
    v_mul_f32 v82, v82, v11
    v_mul_f32 v83, v83, v11
    v_mul_f32 v84, v84, v11
    v_mul_f32 v85, v85, v11
    v_mul_f32 v86, v86, v11
    ds_read_b64_tr_b16 v[96:97], v6 offset:45056
    ds_read_b64_tr_b16 v[98:99], v6 offset:45312
    s_waitcnt lgkmcnt(8)
    v_mfma_f32_32x32x16_bf16 v[64:79], v[232:235], v[100:103], v[64:79]
    v_mul_f32 v87, v87, v11
    v_cvt_pk_bf16_f32 v48, v88, v89
    v_cvt_pk_bf16_f32 v49, v90, v91
    v_cvt_pk_bf16_f32 v50, v92, v93
    v_cvt_pk_bf16_f32 v51, v94, v95
    v_cvt_pk_bf16_f32 v52, v80, v81
    v_cvt_pk_bf16_f32 v53, v82, v83
    v_cvt_pk_bf16_f32 v54, v84, v85
    v_cvt_pk_bf16_f32 v55, v86, v87
    ds_read_b64_tr_b16 v[100:101], v7 offset:45056
    ds_read_b64_tr_b16 v[102:103], v7 offset:45312
    s_waitcnt lgkmcnt(8)
    v_mfma_f32_32x32x16_bf16 v[64:79], v[236:239], v[104:107], v[64:79]
    s_nop 1
    v_mfma_f32_32x32x16_bf16 v[32:47], v[56:59], v[120:123], 0
    v_mfma_f32_32x32x16_bf16 v[32:47], v[60:63], v[124:127], v[32:47]
    s_nop 1
    v_mfma_f32_32x32x16_bf16 v[80:95], v[48:51], v[120:123], 0
    v_mfma_f32_32x32x16_bf16 v[80:95], v[52:55], v[124:127], v[80:95]
    s_lshl_b32 s38, s26, 10
    s_lshl_b32 s39, s25, 2
    s_add_u32 s38, s38, s39
    s_add_u32 s38, s38, 137216
    v_and_b32 v8, 0x1f0, v2
    v_add_u32 v8, s38, v8
    s_waitcnt lgkmcnt(6)
    v_mfma_f32_32x32x16_bf16 v[64:79], v[240:243], v[108:111], v[64:79]
    v_mfma_f32_16x16x32_bf16 v[20:23], v[16:19], v[108:111], v[20:23]
    s_nop 0
    v_cvt_pk_bf16_f32 v56, v32, v33
    v_cvt_pk_bf16_f32 v57, v34, v35
    v_cvt_pk_bf16_f32 v58, v36, v37
    v_cvt_pk_bf16_f32 v59, v38, v39
    v_cvt_pk_bf16_f32 v60, v40, v41
    v_cvt_pk_bf16_f32 v61, v42, v43
    v_cvt_pk_bf16_f32 v62, v44, v45
    v_cvt_pk_bf16_f32 v63, v46, v47
    v_cvt_pk_bf16_f32 v48, v80, v81
    s_waitcnt lgkmcnt(4)
    v_mfma_f32_32x32x16_bf16 v[64:79], v[244:247], v[112:115], v[64:79]
    v_cvt_pk_bf16_f32 v49, v82, v83
    v_cvt_pk_bf16_f32 v50, v84, v85
    v_cvt_pk_bf16_f32 v51, v86, v87
    v_cvt_pk_bf16_f32 v52, v88, v89
    v_cvt_pk_bf16_f32 v53, v90, v91
    v_cvt_pk_bf16_f32 v54, v92, v93
    v_cvt_pk_bf16_f32 v55, v94, v95
    s_nop 1
    v_mfma_f32_16x16x32_bf16 v[36:39], v[16:19], v[56:59], 0
    v_mfma_f32_16x16x32_bf16 v[36:39], v[16:19], v[60:63], v[36:39]
    s_waitcnt lgkmcnt(2)
    v_mfma_f32_32x32x16_bf16 v[64:79], v[248:251], v[96:99], v[64:79]
    s_nop 1
    v_mfma_f32_16x16x32_bf16 v[32:35], v[16:19], v[48:51], 0
    v_mfma_f32_16x16x32_bf16 v[32:35], v[16:19], v[52:55], v[32:35]
    s_nop 7
    ds_write_b32 v8, v32 offset:0
    ds_write_b32 v8, v36 offset:512
    s_waitcnt lgkmcnt(0)
    v_mfma_f32_32x32x16_bf16 v[80:95], v[252:255], v[100:103], v[64:79]
    v_xor_b32 v4, 0x10000, v4
    v_xor_b32 v5, 0x10000, v5
    v_xor_b32 v6, 0x10000, v6
    v_xor_b32 v7, 0x10000, v7
    ds_write_b32 v14, v20
    v_xor_b32 v14, 1024, v14
    v_xor_b32 v15, 1024, v15
    s_lshl_b32 s38, s26, 15
    s_lshl_b32 s39, s25, 12
    s_add_u32 s38, s38, s39
    s_add_u32 s38, s38, 65536
    v_add_u32 v9, s38, v2
    s_waitcnt vmcnt(0) lgkmcnt(0)
    v_mov_b32 v13, v3
    s_cmp_lg_u32 s24, 7
    s_cbranch_scc1 X7
    s_waitcnt vmcnt(0)
    s_mov_b32 s3, 0
C8:
    s_movk_i32 s39, 64
    v_cmp_gt_u32 s[62:63], s39, v13
    s_nop 0
    s_and_b32 s38, s62, 0x3
    s_cbranch_scc0 C9
    s_sleep 8
    v_lshlrev_b32 v12, 7, v1
    s_mov_b64 exec, 3
    buffer_load_dword v13, v12, s[4:7], 0 offen sc1
    s_mov_b64 exec, -1
    s_add_u32 s3, s3, 1
    s_cmp_lt_u32 s3, 20000
    s_waitcnt vmcnt(0)
    s_cbranch_scc1 C8
C9:
X7:
    v_lshrrev_b32 v3, 3, v1
    v_lshlrev_b32 v3, 10, v3
    v_and_b32 v10, 7, v1
    v_bfe_u32 v11, v1, 4, 1
    v_lshlrev_b32 v11, 2, v11
    v_xor_b32 v11, v10, v11
    v_lshl_add_u32 v3, v11, 4, v3
    v_lshrrev_b32 v10, 1, v1
    v_lshlrev_b32 v10, 9, v10
    v_and_b32 v11, 1, v1
    v_lshl_add_u32 v10, v11, 7, v10
    s_lshl_b32 s38, s26, 15
    s_lshl_b32 s39, s25, 10
    s_add_u32 s38, s38, s39
    s_add_u32 s38, s38, 65536
    v_add_u32 v12, s38, v2
    s_and_b32 s40, s25, 1
    s_lshl_b32 s38, s26, 1
    s_add_u32 s40, s40, s38
    s_lshl_b32 s38, s40, 9
    s_add_u32 s38, s38, 137216
    v_and_b32 v8, 0x1f0, v2
    v_add_u32 v8, s38, v8
    s_lshl_b32 s50, s28, 17
    s_lshl_b32 s38, s27, 14
    s_add_u32 s50, s50, s38
    s_add_u32 s50, s50, 20971520
    s_lshl_b32 s40, s40, 7
    s_add_u32 s40, s40, s50
    s_add_u32 s40, s40, 8192
    s_lshl_b32 s38, s24, 10
    s_add_u32 s50, s50, s38
    s_cmp_lg_u32 s77, 0
    s_cselect_b64 vcc, -1, 0
    s_barrier
    ds_read_b128 v[124:127], v15
    ds_read_b128 v[32:35], v31 offset:0
    ds_read_b128 v[36:39], v31 offset:32
    ds_read_b128 v[40:43], v31 offset:64
    ds_read_b128 v[44:47], v31 offset:96
    ds_read_b64_tr_b16 v[96:97], v4 offset:0
    ds_read_b64_tr_b16 v[98:99], v4 offset:256
    ds_read_b64_tr_b16 v[100:101], v5 offset:0
    ds_read_b64_tr_b16 v[102:103], v5 offset:256
    ds_read_b64_tr_b16 v[104:105], v6 offset:0
    ds_read_b64_tr_b16 v[106:107], v6 offset:256
    ds_read_b64_tr_b16 v[108:109], v7 offset:0
    ds_read_b64_tr_b16 v[110:111], v7 offset:256
    ds_read_b64_tr_b16 v[112:113], v4 offset:4096
    ds_read_b64_tr_b16 v[114:115], v4 offset:4352
    s_waitcnt lgkmcnt(8)
    v_mfma_f32_32x32x16_bf16 v[64:79], v[96:99], v[128:131], 0
    v_mfma_f32_16x16x32_bf16 v[20:23], v[16:19], v[96:99], 0
    s_add_u32 m0, s68, 81920
    s_add_u32 s38, s69, 0
    buffer_load_dwordx4 v3, s[64:67], s38 offen lds
    v_add_f32 v124, v124, v125
    v_add_f32 v126, v126, v127
    v_add_f32 v124, v124, v126
    v_cvt_pk_bf16_f32 v125, v124, v124
    v_and_b32 v125, s37, v125
    v_sub_f32 v125, v124, v125
    v_cvt_pk_bf16_f32 v24, v124, v125
    v_and_b32 v124, s37, v24
    ds_read_b64_tr_b16 v[96:97], v5 offset:4096
    ds_read_b64_tr_b16 v[98:99], v5 offset:4352
    s_waitcnt lgkmcnt(8)
    v_mfma_f32_32x32x16_bf16 v[64:79], v[100:103], v[132:135], v[64:79]
    s_add_u32 m0, s68, 90112
    s_add_u32 s38, s69, 16384
    buffer_load_dwordx4 v3, s[64:67], s38 offen lds
    v_sub_f32 v125, v125, v124
    v_cvt_pk_bf16_f32 v25, v125, 0
    s_nop 1
    v_mfma_f32_32x32x16_bf16 v[80:95], v[26:29], v[24:27], v[80:95]
    ds_read_b64_tr_b16 v[100:101], v6 offset:4096
    ds_read_b64_tr_b16 v[102:103], v6 offset:4352
    s_waitcnt lgkmcnt(8)
    v_mfma_f32_32x32x16_bf16 v[64:79], v[104:107], v[136:139], v[64:79]
    s_add_u32 m0, s68, 114688
    s_add_u32 s38, s69, 32768
    buffer_load_dwordx4 v3, s[64:67], s38 offen lds
    s_nop 4
    v_mul_f32 v80, v80, v32
    v_mul_f32 v81, v81, v33
    v_mul_f32 v82, v82, v34
    v_mul_f32 v83, v83, v35
    v_mul_f32 v84, v84, v36
    v_mul_f32 v85, v85, v37
    v_mul_f32 v86, v86, v38
    ds_read_b64_tr_b16 v[104:105], v7 offset:4096
    ds_read_b64_tr_b16 v[106:107], v7 offset:4352
    s_waitcnt lgkmcnt(8)
    v_mfma_f32_32x32x16_bf16 v[64:79], v[108:111], v[140:143], v[64:79]
    s_add_u32 m0, s68, 122880
    s_add_u32 s38, s69, 49152
    buffer_load_dwordx4 v3, s[64:67], s38 offen lds
    v_mul_f32 v87, v87, v39
    v_mul_f32 v88, v88, v40
    v_mul_f32 v89, v89, v41
    v_mul_f32 v90, v90, v42
    v_mul_f32 v91, v91, v43
    v_mul_f32 v92, v92, v44
    v_mul_f32 v93, v93, v45
    v_mul_f32 v94, v94, v46
    v_mul_f32 v95, v95, v47
    ds_read_b64_tr_b16 v[108:109], v4 offset:8192
    ds_read_b64_tr_b16 v[110:111], v4 offset:8448
    s_waitcnt lgkmcnt(8)
    v_mfma_f32_32x32x16_bf16 v[64:79], v[112:115], v[144:147], v[64:79]
    v_mfma_f32_16x16x32_bf16 v[20:23], v[16:19], v[112:115], v[20:23]
    s_add_u32 m0, s68, 139264
    s_add_u32 s38, s69, 262144
    buffer_load_dwordx4 v3, s[64:67], s38 offen lds
    v_cvt_pk_bf16_f32 v120, v80, v81
    v_cvt_pk_bf16_f32 v121, v82, v83
    v_cvt_pk_bf16_f32 v122, v84, v85
    v_cvt_pk_bf16_f32 v123, v86, v87
    v_cvt_pk_bf16_f32 v124, v88, v89
    v_cvt_pk_bf16_f32 v125, v90, v91
    v_cvt_pk_bf16_f32 v126, v92, v93
    v_cvt_pk_bf16_f32 v127, v94, v95
    ds_read_b64_tr_b16 v[112:113], v5 offset:8192
    ds_read_b64_tr_b16 v[114:115], v5 offset:8448
    s_waitcnt lgkmcnt(8)
    v_mfma_f32_32x32x16_bf16 v[64:79], v[96:99], v[148:151], v[64:79]
    s_add_u32 m0, s68, 147456
    s_add_u32 s38, s69, 278528
    buffer_load_dwordx4 v3, s[64:67], s38 offen lds
    v_cndmask_b32 v32, 0, v120, s[58:59]
    v_cndmask_b32 v33, 0, v121, s[58:59]
    v_cndmask_b32 v34, 0, v122, s[58:59]
    v_cndmask_b32 v35, 0, v123, s[58:59]
    v_cndmask_b32 v36, 0, v124, s[58:59]
    v_cndmask_b32 v37, 0, v125, s[58:59]
    v_cndmask_b32 v38, 0, v126, s[58:59]
    v_cndmask_b32 v39, 0, v127, s[58:59]
    ds_read_b64_tr_b16 v[96:97], v6 offset:8192
    ds_read_b64_tr_b16 v[98:99], v6 offset:8448
    s_waitcnt lgkmcnt(8)
    v_mfma_f32_32x32x16_bf16 v[64:79], v[100:103], v[152:155], v[64:79]
    s_add_u32 m0, s68, 155648
    s_add_u32 s38, s69, 294912
    buffer_load_dwordx4 v3, s[64:67], s38 offen lds
    s_nop 1
    v_mfma_f32_32x32x16_bf16 v[80:95], v[48:51], v[32:35], 0
    v_mfma_f32_32x32x16_bf16 v[80:95], v[52:55], v[36:39], v[80:95]
    v_cndmask_b32 v40, v120, 0, s[58:59]
    v_cndmask_b32 v41, v121, 0, s[58:59]
    v_cndmask_b32 v42, v122, 0, s[58:59]
    v_cndmask_b32 v43, v123, 0, s[58:59]
    v_cndmask_b32 v44, v124, 0, s[58:59]
    ds_read_b64_tr_b16 v[100:101], v7 offset:8192
    ds_read_b64_tr_b16 v[102:103], v7 offset:8448
    s_waitcnt lgkmcnt(8)
    v_mfma_f32_32x32x16_bf16 v[64:79], v[104:107], v[156:159], v[64:79]
    v_cndmask_b32 v45, v125, 0, s[58:59]
    v_cndmask_b32 v46, v126, 0, s[58:59]
    v_cndmask_b32 v47, v127, 0, s[58:59]
    s_nop 1
    v_mfma_f32_32x32x16_bf16 v[80:95], v[56:59], v[40:43], v[80:95]
    v_mfma_f32_32x32x16_bf16 v[80:95], v[60:63], v[44:47], v[80:95]
    ds_read_b64_tr_b16 v[104:105], v4 offset:12288
    ds_read_b64_tr_b16 v[106:107], v4 offset:12544
    s_waitcnt lgkmcnt(8)
    v_mfma_f32_32x32x16_bf16 v[64:79], v[108:111], v[160:163], v[64:79]
    v_mfma_f32_16x16x32_bf16 v[20:23], v[16:19], v[108:111], v[20:23]
    s_nop 6
    ds_write_b128 v9, v[80:83] offset:0
    ds_write_b128 v9, v[84:87] offset:1024
    ds_write_b128 v9, v[88:91] offset:2048
    ds_write_b128 v9, v[92:95] offset:3072
    s_waitcnt lgkmcnt(0)
    s_barrier
    ds_read_b128 v[32:35], v12 offset:0
    ds_read_b128 v[36:39], v12 offset:4096
    ds_read_b128 v[40:43], v12 offset:8192
    ds_read_b128 v[44:47], v12 offset:12288
    ds_read_b128 v[48:51], v8
    v_lshlrev_b32 v12, 2, v1
    ds_read_b64_tr_b16 v[108:109], v5 offset:12288
    ds_read_b64_tr_b16 v[110:111], v5 offset:12544
    s_waitcnt lgkmcnt(8)
    v_mfma_f32_32x32x16_bf16 v[64:79], v[112:115], v[164:167], v[64:79]
    ds_read_b64_tr_b16 v[112:113], v6 offset:12288
    ds_read_b64_tr_b16 v[114:115], v6 offset:12544
    s_waitcnt lgkmcnt(8)
    v_mfma_f32_32x32x16_bf16 v[64:79], v[96:99], v[168:171], v[64:79]
    ds_read_b64_tr_b16 v[96:97], v7 offset:12288
    ds_read_b64_tr_b16 v[98:99], v7 offset:12544
    s_waitcnt lgkmcnt(8)
    v_mfma_f32_32x32x16_bf16 v[64:79], v[100:103], v[172:175], v[64:79]
    ds_read_b64_tr_b16 v[100:101], v4 offset:32768
    ds_read_b64_tr_b16 v[102:103], v4 offset:33024
    s_waitcnt lgkmcnt(8)
    v_mfma_f32_32x32x16_bf16 v[64:79], v[104:107], v[176:179], v[64:79]
    v_mfma_f32_16x16x32_bf16 v[20:23], v[16:19], v[104:107], v[20:23]
    ds_read_b64_tr_b16 v[104:105], v5 offset:32768
    ds_read_b64_tr_b16 v[106:107], v5 offset:33024
    s_waitcnt lgkmcnt(8)
    v_mfma_f32_32x32x16_bf16 v[64:79], v[108:111], v[180:183], v[64:79]
    v_add_f32 v32, v32, v36
    v_add_f32 v33, v33, v37
    v_add_f32 v34, v34, v38
    v_add_f32 v35, v35, v39
    v_add_f32 v40, v40, v44
    v_add_f32 v41, v41, v45
    ds_read_b64_tr_b16 v[108:109], v6 offset:32768
    ds_read_b64_tr_b16 v[110:111], v6 offset:33024
    s_waitcnt lgkmcnt(8)
    v_mfma_f32_32x32x16_bf16 v[64:79], v[112:115], v[184:187], v[64:79]
    v_add_f32 v42, v42, v46
    v_add_f32 v43, v43, v47
    v_add_f32 v32, v32, v40
    v_add_f32 v33, v33, v41
    v_add_f32 v34, v34, v42
    v_add_f32 v35, v35, v43
    ds_read_b64_tr_b16 v[112:113], v7 offset:32768
    ds_read_b64_tr_b16 v[114:115], v7 offset:33024
    s_waitcnt lgkmcnt(8)
    v_mfma_f32_32x32x16_bf16 v[64:79], v[96:99], v[188:191], v[64:79]
    buffer_store_dwordx4 v[32:35], v2, s[16:19], s50 offen sc1
    v_add_f32 v48, v48, v49
    v_add_f32 v50, v50, v51
    v_add_f32 v48, v48, v50
    s_cmp_ge_u32 s25, 2
    s_cbranch_scc1 K_QNZ
    s_mov_b32 exec_hi, 0
    buffer_store_dword v48, v12, s[16:19], s40 offen sc1
    s_mov_b32 exec_hi, -1
K_QNZ:
    ds_read_b64_tr_b16 v[96:97], v4 offset:36864
    ds_read_b64_tr_b16 v[98:99], v4 offset:37120
    s_waitcnt lgkmcnt(8)
    v_mfma_f32_32x32x16_bf16 v[64:79], v[100:103], v[192:195], v[64:79]
    v_mfma_f32_16x16x32_bf16 v[20:23], v[16:19], v[100:103], v[20:23]
    s_barrier
    ds_read_b64_tr_b16 v[100:101], v5 offset:36864
    ds_read_b64_tr_b16 v[102:103], v5 offset:37120
    s_waitcnt lgkmcnt(8)
    v_mfma_f32_32x32x16_bf16 v[64:79], v[104:107], v[196:199], v[64:79]
    s_add_u32 m0, s68, 0
    s_add_u32 s38, s69, 311296
    buffer_load_dwordx4 v3, s[64:67], s38 offen lds
    ds_read_b64_tr_b16 v[104:105], v6 offset:36864
    ds_read_b64_tr_b16 v[106:107], v6 offset:37120
    s_waitcnt lgkmcnt(8)
    v_mfma_f32_32x32x16_bf16 v[64:79], v[108:111], v[200:203], v[64:79]
    s_add_u32 m0, s68, 8192
    s_add_u32 s38, s69, 65536
    buffer_load_dwordx4 v3, s[64:67], s38 offen lds
    s_lshl_b32 s61, s77, 2
    s_add_u32 s61, s61, s25
    s_cmp_ge_u32 s61, 2
    s_cbranch_scc1 K_QRA
    s_lshl_b32 s30, s27, 4
    s_add_u32 s30, s30, s28
    s_lshl_b32 s30, s30, 1
    s_add_u32 s30, s30, s25
    v_lshrrev_b32 v124, 4, v1
    v_and_b32 v125, 15, v1
    v_lshlrev_b32 v125, 4, v125
    v_lshl_add_u32 v122, v124, 2, v125
    s_lshl_b32 s57, s27, 14
    s_add_u32 s57, s57, 20971520
    s_cmp_eq_u32 s25, 0
    s_cbranch_scc0 K_GZA
    s_and_b32 s38, s28, 8
    s_lshl_b32 s38, s38, 9
    s_add_u32 s57, s57, s38
    s_and_b32 s38, s28, 2
    s_lshl_b32 s38, s38, 10
    s_add_u32 s57, s57, s38
    s_and_b32 s38, s28, 1
    s_lshl_b32 s38, s38, 9
    s_add_u32 s57, s57, s38
    s_and_b32 s38, s28, 4
    s_lshl_b32 s38, s38, 6
    s_add_u32 s57, s57, s38
    v_lshl_add_u32 v120, v124, 17, v125
    v_add_u32 v121, 1024, v120
    s_branch K_GZB
K_GZA:
    s_lshr_b32 s38, s28, 1
    s_lshl_b32 s38, s38, 6
    s_add_u32 s57, s57, s38
    s_and_b32 s38, s28, 1
    s_lshl_b32 s38, s38, 4
    s_add_u32 s57, s57, s38
    s_add_u32 s57, s57, 8192
    v_lshlrev_b32 v120, 17, v124
    v_add_u32 v121, 32, v120
K_GZB:
K_QRA:
    ds_read_b64_tr_b16 v[108:109], v7 offset:36864
    ds_read_b64_tr_b16 v[110:111], v7 offset:37120
    s_waitcnt lgkmcnt(8)
    v_mfma_f32_32x32x16_bf16 v[64:79], v[112:115], v[204:207], v[64:79]
    s_add_u32 m0, s68, 16384
    s_add_u32 s38, s69, 81920
    buffer_load_dwordx4 v3, s[64:67], s38 offen lds
    ds_read_b64_tr_b16 v[112:113], v4 offset:40960
    ds_read_b64_tr_b16 v[114:115], v4 offset:41216
    s_waitcnt lgkmcnt(8)
    v_mfma_f32_32x32x16_bf16 v[64:79], v[96:99], v[208:211], v[64:79]
    v_mfma_f32_16x16x32_bf16 v[20:23], v[16:19], v[96:99], v[20:23]
    s_add_u32 m0, s68, 24576
    s_add_u32 s38, s69, 98304
    buffer_load_dwordx4 v3, s[64:67], s38 offen lds
    ds_read_b64_tr_b16 v[96:97], v5 offset:40960
    ds_read_b64_tr_b16 v[98:99], v5 offset:41216
    s_waitcnt lgkmcnt(8)
    v_mfma_f32_32x32x16_bf16 v[64:79], v[100:103], v[212:215], v[64:79]
    ds_read_b64_tr_b16 v[100:101], v6 offset:40960
    ds_read_b64_tr_b16 v[102:103], v6 offset:41216
    s_waitcnt lgkmcnt(8)
    v_mfma_f32_32x32x16_bf16 v[64:79], v[104:107], v[216:219], v[64:79]
    ds_read_b64_tr_b16 v[104:105], v7 offset:40960
    ds_read_b64_tr_b16 v[106:107], v7 offset:41216
    s_waitcnt lgkmcnt(8)
    v_mfma_f32_32x32x16_bf16 v[64:79], v[108:111], v[220:223], v[64:79]
    ds_read_b64_tr_b16 v[108:109], v4 offset:45056
    ds_read_b64_tr_b16 v[110:111], v4 offset:45312
    s_waitcnt lgkmcnt(8)
    v_mfma_f32_32x32x16_bf16 v[64:79], v[112:115], v[224:227], v[64:79]
    v_mfma_f32_16x16x32_bf16 v[20:23], v[16:19], v[112:115], v[20:23]
    ds_read_b64_tr_b16 v[112:113], v5 offset:45056
    ds_read_b64_tr_b16 v[114:115], v5 offset:45312
    s_waitcnt lgkmcnt(8)
    v_mfma_f32_32x32x16_bf16 v[64:79], v[96:99], v[228:231], v[64:79]
    ds_read_b64_tr_b16 v[96:97], v6 offset:45056
    ds_read_b64_tr_b16 v[98:99], v6 offset:45312
    s_waitcnt lgkmcnt(8)
    v_mfma_f32_32x32x16_bf16 v[64:79], v[100:103], v[232:235], v[64:79]
    ds_read_b64_tr_b16 v[100:101], v7 offset:45056
    ds_read_b64_tr_b16 v[102:103], v7 offset:45312
    s_waitcnt lgkmcnt(8)
    v_mfma_f32_32x32x16_bf16 v[64:79], v[104:107], v[236:239], v[64:79]
    s_waitcnt lgkmcnt(6)
    v_mfma_f32_32x32x16_bf16 v[64:79], v[108:111], v[240:243], v[64:79]
    v_mfma_f32_16x16x32_bf16 v[20:23], v[16:19], v[108:111], v[20:23]
    s_waitcnt lgkmcnt(4)
    v_mfma_f32_32x32x16_bf16 v[64:79], v[112:115], v[244:247], v[64:79]
    s_waitcnt vmcnt(0)
    s_cbranch_vccz G10
    s_mov_b64 exec, 0xff
    buffer_load_dword v11, v10, s[16:19], s57 offen sc1
    s_mov_b64 exec, -1
G10:
    s_waitcnt lgkmcnt(2)
    v_mfma_f32_32x32x16_bf16 v[64:79], v[96:99], v[248:251], v[64:79]
    s_cmp_ge_u32 s61, 2
    s_cbranch_scc1 K_QRL
    s_mov_b32 s38, s57
    buffer_load_dwordx4 v[128:131], v120, s[16:19], s38 offen sc1
    buffer_load_dwordx4 v[132:135], v121, s[16:19], s38 offen sc1
    s_add_u32 s38, s38, 524288
    buffer_load_dwordx4 v[136:139], v120, s[16:19], s38 offen sc1
    buffer_load_dwordx4 v[140:143], v121, s[16:19], s38 offen sc1
    s_add_u32 s38, s38, 524288
    buffer_load_dwordx4 v[144:147], v120, s[16:19], s38 offen sc1
    buffer_load_dwordx4 v[148:151], v121, s[16:19], s38 offen sc1
    s_add_u32 s38, s38, 524288
    buffer_load_dwordx4 v[152:155], v120, s[16:19], s38 offen sc1
    buffer_load_dwordx4 v[156:159], v121, s[16:19], s38 offen sc1
K_QRL:
    s_waitcnt lgkmcnt(0)
    v_mfma_f32_32x32x16_bf16 v[80:95], v[100:103], v[252:255], v[64:79]
    v_xor_b32 v4, 0x10000, v4
    v_xor_b32 v5, 0x10000, v5
    v_xor_b32 v6, 0x10000, v6
    v_xor_b32 v7, 0x10000, v7
    ds_write_b32 v14, v20
    v_xor_b32 v14, 1024, v14
    v_xor_b32 v15, 1024, v15
    s_waitcnt lgkmcnt(0)
    s_barrier
    ds_read_b128 v[48:51], v15
    s_cmp_lg_u32 s77, 0
    s_cselect_b64 vcc, -1, 0
    s_mov_b32 s12, s96
    s_mov_b32 s13, s97
    s_mov_b32 s14, 0x1c0000
    s_mov_b32 s15, 0x00020000
    s_mov_b32 s20, s98
    s_mov_b32 s21, s99
    s_mov_b32 s22, 0x80000
    s_mov_b32 s23, 0x00020000
    s_lshr_b32 s39, s32, 2
    s_lshl_b32 s39, s39, 7
    s_lshl_b32 s54, s25, 17
    s_add_u32 s54, s54, s39
    v_lshrrev_b32 v6, 3, v1
    v_lshlrev_b32 v6, 10, v6
    v_and_b32 v4, 7, v1
    v_bfe_u32 v5, v1, 4, 1
    v_lshlrev_b32 v5, 2, v5
    v_xor_b32 v5, v4, v5
    v_lshl_add_u32 v3, v5, 4, v6
    v_lshl_add_u32 v6, v4, 4, v6
    s_lshr_b32 s39, s27, 2
    s_lshl_b32 s39, s39, 1
    s_lshl_b32 s40, s28, 2
    s_add_u32 s39, s39, s40
    s_lshr_b32 s38, s39, 1
    s_and_b32 s38, s38, 6
    s_and_b32 s62, s39, 1
    s_or_b32 s38, s38, s62
    s_cmp_eq_u32 s38, 3
    s_cselect_b32 s38, 7, s38
    s_lshl_b32 s38, s38, 7
    s_add_u32 s38, s38, 640
    s_mov_b32 s62, 0xff000000
    s_mov_b32 s63, 0
    v_mov_b32 v238, s38
    v_cndmask_b32 v238, 0, v238, s[62:63]
    v_add_u32 v238, v238, v2
    s_and_b32 s38, s39, 1
    s_lshl_b32 s38, s38, 10
    v_xor_b32 v238, s38, v238
    s_add_u32 s39, s39, 1
    s_lshr_b32 s38, s39, 1
    s_and_b32 s38, s38, 6
    s_and_b32 s62, s39, 1
    s_or_b32 s38, s38, s62
    s_cmp_eq_u32 s38, 3
    s_cselect_b32 s38, 7, s38
    s_lshl_b32 s38, s38, 7
    s_add_u32 s38, s38, 640
    s_mov_b32 s62, 0xff000000
    s_mov_b32 s63, 0
    v_mov_b32 v239, s38
    v_cndmask_b32 v239, 0, v239, s[62:63]
    v_add_u32 v239, v239, v2
    s_and_b32 s38, s39, 1
    s_lshl_b32 s38, s38, 10
    v_xor_b32 v239, s38, v239
    s_mul_i32 s38, s25, 3072
    s_add_u32 s38, s38, 49152
    v_add_u32 v9, s38, v2
    s_lshl_b32 s38, s25, 2
    s_add_u32 s38, s38, 136224
    v_mov_b32 v12, s38
    s_waitcnt lgkmcnt(0)
    s_cbranch_vccz K_QG
    s_waitcnt vmcnt(0)
    s_mov_b32 s3, 0
C11:
    s_movk_i32 s39, 1
    v_cmp_gt_u32 s[62:63], s39, v11
    s_nop 0
    s_and_b32 s38, s62, 0xff
    s_cbranch_scc0 C12
    s_sleep 8
    s_mov_b64 exec, 0xff
    buffer_load_dword v11, v10, s[16:19], s57 offen sc1
    s_mov_b64 exec, -1
    s_add_u32 s3, s3, 1
    s_cmp_lt_u32 s3, 20000
    s_waitcnt vmcnt(0)
    s_cbranch_scc1 C11
C12:
    s_add_u32 s41, s30, 0
    s_add_u32 s42, s33, 0
    buffer_load_dwordx4 v[128:131], v238, s[16:19], s41 offen offset:0 sc1
    v_add_f32 v48, v48, v49
    v_add_f32 v50, v50, v51
    v_add_f32 v48, v48, v50
    v_cvt_pk_bf16_f32 v49, v48, v48
    buffer_load_dwordx4 v[132:135], v239, s[16:19], s42 offen offset:0 sc1
    v_and_b32 v49, s37, v49
    v_sub_f32 v49, v48, v49
    v_cvt_pk_bf16_f32 v24, v48, v49
    buffer_load_dwordx4 v[136:139], v238, s[16:19], s41 offen offset:2048 sc1
    v_and_b32 v48, s37, v24
    v_sub_f32 v49, v49, v48
    v_cvt_pk_bf16_f32 v25, v49, 0
    s_nop 1
    v_mfma_f32_32x32x16_bf16 v[80:95], v[24:27], v[26:29], v[80:95]
    buffer_load_dwordx4 v[140:143], v239, s[16:19], s42 offen offset:2048 sc1
    s_add_u32 s41, s30, 4096
    s_add_u32 s42, s33, 4096
    buffer_load_dwordx4 v[144:147], v238, s[16:19], s41 offen offset:0 sc1
    s_nop 8
    v_cvt_pk_bf16_f32 v56, v80, v81
    v_cvt_pk_bf16_f32 v57, v82, v83
    buffer_load_dwordx4 v[148:151], v239, s[16:19], s42 offen offset:0 sc1
    v_cvt_pk_bf16_f32 v58, v84, v85
    v_cvt_pk_bf16_f32 v59, v86, v87
    v_cvt_pk_bf16_f32 v60, v88, v89
    buffer_load_dwordx4 v[152:155], v238, s[16:19], s41 offen offset:2048 sc1
    v_cvt_pk_bf16_f32 v61, v90, v91
    v_cvt_pk_bf16_f32 v62, v92, v93
    v_cvt_pk_bf16_f32 v63, v94, v95
    ds_write_b128 v9, v[56:59]
    buffer_load_dwordx4 v[156:159], v239, s[16:19], s42 offen offset:2048 sc1
    ds_write_b128 v9, v[60:63] offset:1024
    ds_write_b128 v9, v[116:119] offset:2048
    v_mov_b32 v13, 1
    s_waitcnt lgkmcnt(0)
    ds_write_b32 v12, v13
    s_add_u32 s41, s30, 32768
    s_add_u32 s42, s33, 32768
    buffer_load_dwordx4 v[160:163], v238, s[16:19], s41 offen offset:0 sc1
    buffer_load_dwordx4 v[164:167], v239, s[16:19], s42 offen offset:0 sc1
    buffer_load_dwordx4 v[168:171], v238, s[16:19], s41 offen offset:2048 sc1
    buffer_load_dwordx4 v[172:175], v239, s[16:19], s42 offen offset:2048 sc1
    s_add_u32 s41, s30, 36864
    s_add_u32 s42, s33, 36864
    buffer_load_dwordx4 v[176:179], v238, s[16:19], s41 offen offset:0 sc1
    buffer_load_dwordx4 v[180:183], v239, s[16:19], s42 offen offset:0 sc1
    buffer_load_dwordx4 v[184:187], v238, s[16:19], s41 offen offset:2048 sc1
    buffer_load_dwordx4 v[188:191], v239, s[16:19], s42 offen offset:2048 sc1
    s_add_u32 s41, s30, 8192
    s_add_u32 s42, s33, 8192
    buffer_load_dwordx4 v[192:195], v238, s[16:19], s41 offen offset:0 sc1
    buffer_load_dwordx4 v[196:199], v239, s[16:19], s42 offen offset:0 sc1
    buffer_load_dwordx4 v[200:203], v238, s[16:19], s41 offen offset:2048 sc1
    buffer_load_dwordx4 v[204:207], v239, s[16:19], s42 offen offset:2048 sc1
    s_add_u32 s41, s30, 12288
    s_add_u32 s42, s33, 12288
    buffer_load_dwordx4 v[208:211], v238, s[16:19], s41 offen offset:0 sc1
    buffer_load_dwordx4 v[212:215], v239, s[16:19], s42 offen offset:0 sc1
    buffer_load_dwordx4 v[216:219], v238, s[16:19], s41 offen offset:2048 sc1
    buffer_load_dwordx4 v[220:223], v239, s[16:19], s42 offen offset:2048 sc1
    s_add_u32 m0, s34, 32768
    s_add_u32 s38, s43, 114688
    buffer_load_dwordx4 v3, s[12:15], s38 offen lds
    s_add_u32 m0, s34, 33792
    s_add_u32 s38, s43, 122880
    buffer_load_dwordx4 v3, s[12:15], s38 offen lds
    s_add_u32 m0, s34, 40960
    s_add_u32 s38, s43, 327680
    buffer_load_dwordx4 v3, s[12:15], s38 offen lds
    s_add_u32 m0, s34, 41984
    s_add_u32 s38, s43, 335872
    buffer_load_dwordx4 v3, s[12:15], s38 offen lds
    s_branch K_P2
K_QG:
    s_setprio 2
    v_mov_b32 v112, v9
    v_mov_b32 v114, v12
    v_add_f32 v48, v48, v49
    v_add_f32 v50, v50, v51
    v_add_f32 v48, v48, v50
    v_cvt_pk_bf16_f32 v49, v48, v48
    v_and_b32 v49, s37, v49
    v_sub_f32 v49, v48, v49
    v_cvt_pk_bf16_f32 v24, v48, v49
    v_and_b32 v48, s37, v24
    v_sub_f32 v49, v49, v48
    v_cvt_pk_bf16_f32 v25, v49, 0
    s_nop 1
    v_mfma_f32_32x32x16_bf16 v[80:95], v[24:27], v[26:29], v[80:95]
    s_nop 11
    v_cvt_pk_bf16_f32 v168, v80, v81
    v_cvt_pk_bf16_f32 v169, v82, v83
    v_cvt_pk_bf16_f32 v170, v84, v85
    v_cvt_pk_bf16_f32 v171, v86, v87
    v_cvt_pk_bf16_f32 v172, v88, v89
    v_cvt_pk_bf16_f32 v173, v90, v91
    v_cvt_pk_bf16_f32 v174, v92, v93
    v_cvt_pk_bf16_f32 v175, v94, v95
    v_mov_b32 v96, 0x21400
    v_mov_b32 v97, 1
    s_and_b32 s38, s25, 1
    s_lshl_b32 s41, s38, 12
    s_xor_b32 s38, s38, s26
    s_lshl_b32 s38, s38, 12
    s_lshl_b32 s40, s27, 13
    s_add_u32 s40, s40, s38
    s_add_u32 s40, s40, 23068672
    s_mov_b32 s33, 0
K_GQ:
    s_nop 1
    v_mfma_f32_32x32x16_bf16 v[32:47], v[116:119], v[172:175], 0
    v_mfma_f32_32x32x16_bf16 v[80:95], v[116:119], v[168:171], 0
    s_nop 10
    v_max3_f32 v8, v40, v41, v42
    v_max3_f32 v9, -v40, -v41, -v42
    v_max3_f32 v8, v8, v43, v44
    v_max3_f32 v9, v9, -v43, -v44
    v_max3_f32 v8, v8, v45, v46
    v_max3_f32 v9, v9, -v45, -v46
    v_max_f32 v8, v8, v47
    v_max_f32_e64 v9, v9, -v47
    s_nop 1
    v_permlane32_swap_b32 v8, v9
    v_max_f32 v8, v8, v9
    v_mul_f32_e64 v8, -v8, v30
    v_mov_b32 v9, v8
    s_nop 1
    v_permlane32_swap_b32 v8, v9
    v_fma_f32 v32, v40, v30, v8
    v_fma_f32 v33, v41, v30, v8
    v_fma_f32 v34, v42, v30, v8
    v_fma_f32 v35, v43, v30, v8
    v_fma_f32 v36, v44, v30, v8
    v_fma_f32 v37, v45, v30, v8
    v_fma_f32 v38, v46, v30, v8
    v_fma_f32 v39, v47, v30, v8
    v_fma_f32 v40, -v40, v30, v9
    v_fma_f32 v41, -v41, v30, v9
    v_fma_f32 v42, -v42, v30, v9
    v_fma_f32 v43, -v43, v30, v9
    v_fma_f32 v44, -v44, v30, v9
    v_fma_f32 v45, -v45, v30, v9
    v_fma_f32 v46, -v46, v30, v9
    v_fma_f32 v47, -v47, v30, v9
    v_exp_f32 v32, v32
    v_exp_f32 v33, v33
    v_exp_f32 v34, v34
    v_exp_f32 v35, v35
    v_exp_f32 v36, v36
    v_exp_f32 v37, v37
    v_exp_f32 v38, v38
    v_exp_f32 v39, v39
    v_exp_f32 v40, v40
    v_exp_f32 v41, v41
    v_exp_f32 v42, v42
    s_add_u32 s38, s25, s33
    s_cmp_ge_u32 s38, 2
    s_cbranch_scc1 R15
    s_waitcnt vmcnt(0)
    s_mov_b32 s3, 0
V13:
    v_max_u32 v98, v128, v129
    v_max3_u32 v98, v98, v130, v131
    v_max3_u32 v98, v98, v132, v133
    v_max3_u32 v98, v98, v134, v135
    v_max3_u32 v98, v98, v136, v137
    v_max3_u32 v98, v98, v138, v139
    v_max3_u32 v98, v98, v140, v141
    v_max3_u32 v98, v98, v142, v143
    v_max3_u32 v98, v98, v144, v145
    v_max3_u32 v98, v98, v146, v147
    v_max3_u32 v98, v98, v148, v149
    v_max3_u32 v98, v98, v150, v151
    v_max3_u32 v98, v98, v152, v153
    v_max3_u32 v98, v98, v154, v155
    v_max3_u32 v98, v98, v156, v157
    v_max3_u32 v98, v98, v158, v159
    v_cmp_eq_u32 vcc, -1, v98
    s_nop 0
    s_cmp_eq_u64 vcc, 0
    s_cbranch_scc1 V14
    s_sleep 8
    s_mov_b32 s38, s57
    buffer_load_dwordx4 v[128:131], v120, s[16:19], s38 offen sc1
    buffer_load_dwordx4 v[132:135], v121, s[16:19], s38 offen sc1
    s_add_u32 s38, s38, 524288
    buffer_load_dwordx4 v[136:139], v120, s[16:19], s38 offen sc1
    buffer_load_dwordx4 v[140:143], v121, s[16:19], s38 offen sc1
    s_add_u32 s38, s38, 524288
    buffer_load_dwordx4 v[144:147], v120, s[16:19], s38 offen sc1
    buffer_load_dwordx4 v[148:151], v121, s[16:19], s38 offen sc1
    s_add_u32 s38, s38, 524288
    buffer_load_dwordx4 v[152:155], v120, s[16:19], s38 offen sc1
    buffer_load_dwordx4 v[156:159], v121, s[16:19], s38 offen sc1
    s_add_u32 s3, s3, 1
    s_cmp_lt_u32 s3, 2500
    s_waitcnt vmcnt(0)
    s_cbranch_scc1 V13
V14:
    s_lshl_b32 s38, s30, 8
    s_add_u32 s38, s38, 23068672
    v_add_f32 v128, v128, v144
    v_add_f32 v129, v129, v145
    v_add_f32 v130, v130, v146
    v_add_f32 v131, v131, v147
    v_add_f32 v132, v132, v148
    v_add_f32 v133, v133, v149
    v_add_f32 v134, v134, v150
    v_add_f32 v135, v135, v151
    v_add_f32 v136, v136, v152
    v_add_f32 v137, v137, v153
    v_add_f32 v138, v138, v154
    v_add_f32 v139, v139, v155
    v_add_f32 v140, v140, v156
    v_add_f32 v141, v141, v157
    v_add_f32 v142, v142, v158
    v_add_f32 v143, v143, v159
    v_add_f32 v128, v128, v136
    v_add_f32 v129, v129, v137
    v_add_f32 v130, v130, v138
    v_add_f32 v131, v131, v139
    v_add_f32 v132, v132, v140
    v_add_f32 v133, v133, v141
    v_add_f32 v134, v134, v142
    v_add_f32 v135, v135, v143
    s_nop 1
    v_permlane32_swap_b32 v128, v132
    v_permlane32_swap_b32 v129, v133
    v_permlane32_swap_b32 v130, v134
    v_permlane32_swap_b32 v131, v135
    v_add_f32 v128, v128, v132
    v_add_f32 v129, v129, v133
    v_add_f32 v130, v130, v134
    v_add_f32 v131, v131, v135
    s_nop 1
    v_permlane16_swap_b32 v128, v130
    v_permlane16_swap_b32 v129, v131
    v_add_f32 v128, v128, v130
    v_add_f32 v129, v129, v131
    v_cvt_pk_bf16_f32 v128, v128, v129
    buffer_store_dword v128, v122, s[16:19], s38 offen sc1
    s_mov_b64 exec, 1
    ds_add_u32 v96, v97
    s_mov_b64 exec, -1
R15:
    v_exp_f32 v43, v43
    v_exp_f32 v44, v44
    v_exp_f32 v45, v45
    v_exp_f32 v46, v46
    v_exp_f32 v47, v47
    v_add_f32 v10, v32, v33
    v_add_f32 v11, v40, v41
    v_add_f32 v12, v34, v35
    v_add_f32 v13, v42, v43
    v_add_f32 v10, v10, v36
    v_add_f32 v11, v11, v44
    v_add_f32 v12, v12, v37
    v_add_f32 v13, v13, v45
    v_add_f32 v10, v10, v38
    v_add_f32 v11, v11, v46
    v_add_f32 v12, v12, v39
    v_add_f32 v13, v13, v47
    v_add_f32 v10, v10, v12
    v_add_f32 v11, v11, v13
    s_nop 1
    v_permlane32_swap_b32 v10, v11
    v_add_f32 v10, v10, v11
    v_rcp_f32 v10, v10
    s_nop 0
    v_mov_b32 v11, v10
    s_nop 1
    v_permlane32_swap_b32 v10, v11
    v_mul_f32 v32, v32, v10
    v_mul_f32 v33, v33, v10
    v_mul_f32 v34, v34, v10
    v_mul_f32 v35, v35, v10
    v_mul_f32 v36, v36, v10
    v_mul_f32 v37, v37, v10
    v_mul_f32 v38, v38, v10
    v_mul_f32 v39, v39, v10
    v_mul_f32 v40, v40, v11
    v_mul_f32 v41, v41, v11
    s_add_u32 s38, s25, s33
    s_cmp_lt_u32 s38, 4
    s_cbranch_scc1 R16
    buffer_load_dwordx4 v[208:211], v2, s[16:19], s40 offen offset:0 sc1
    buffer_load_dwordx4 v[212:215], v2, s[16:19], s40 offen offset:1024 sc1
    buffer_load_dwordx4 v[216:219], v2, s[16:19], s40 offen offset:2048 sc1
    buffer_load_dwordx4 v[220:223], v2, s[16:19], s40 offen offset:3072 sc1
R16:
    v_mul_f32 v42, v42, v11
    v_mul_f32 v43, v43, v11
    v_mul_f32 v44, v44, v11
    v_mul_f32 v45, v45, v11
    v_mul_f32 v46, v46, v11
    v_mul_f32 v47, v47, v11
    v_cvt_pk_bf16_f32 v56, v32, v33
    v_cvt_pk_bf16_f32 v57, v34, v35
    v_cvt_pk_bf16_f32 v58, v36, v37
    v_cvt_pk_bf16_f32 v59, v38, v39
    v_cvt_pk_bf16_f32 v60, v40, v41
    v_cvt_pk_bf16_f32 v61, v42, v43
    v_cvt_pk_bf16_f32 v62, v44, v45
    v_cvt_pk_bf16_f32 v63, v46, v47
    v_max3_f32 v8, v80, v81, v82
    v_max3_f32 v9, -v80, -v81, -v82
    v_max3_f32 v8, v8, v83, v84
    v_max3_f32 v9, v9, -v83, -v84
    v_max3_f32 v8, v8, v85, v86
    v_max3_f32 v9, v9, -v85, -v86
    v_max_f32 v8, v8, v87
    v_max_f32_e64 v9, v9, -v87
    s_nop 1
    v_permlane32_swap_b32 v8, v9
    v_max_f32 v8, v8, v9
    v_mul_f32_e64 v8, -v8, v30
    v_mov_b32 v9, v8
    s_nop 1
    v_permlane32_swap_b32 v8, v9
    v_fma_f32 v88, v80, v30, v8
    v_fma_f32 v89, v81, v30, v8
    v_fma_f32 v90, v82, v30, v8
    v_fma_f32 v91, v83, v30, v8
    v_fma_f32 v92, v84, v30, v8
    v_fma_f32 v93, v85, v30, v8
    v_fma_f32 v94, v86, v30, v8
    v_fma_f32 v95, v87, v30, v8
    v_fma_f32 v80, -v80, v30, v9
    v_fma_f32 v81, -v81, v30, v9
    v_fma_f32 v82, -v82, v30, v9
    v_fma_f32 v83, -v83, v30, v9
    v_fma_f32 v84, -v84, v30, v9
    v_fma_f32 v85, -v85, v30, v9
    v_fma_f32 v86, -v86, v30, v9
    v_fma_f32 v87, -v87, v30, v9
    v_exp_f32 v88, v88
    v_exp_f32 v89, v89
    v_exp_f32 v90, v90
    v_exp_f32 v91, v91
    v_exp_f32 v92, v92
    v_exp_f32 v93, v93
    v_exp_f32 v94, v94
    v_exp_f32 v95, v95
    v_exp_f32 v80, v80
    v_exp_f32 v81, v81
    v_exp_f32 v82, v82
    v_exp_f32 v83, v83
    v_exp_f32 v84, v84
    v_exp_f32 v85, v85
    v_exp_f32 v86, v86
    v_exp_f32 v87, v87
    v_add_f32 v10, v88, v89
    v_add_f32 v11, v80, v81
    v_add_f32 v12, v90, v91
    v_add_f32 v13, v82, v83
    v_add_f32 v10, v10, v92
    v_add_f32 v11, v11, v84
    v_add_f32 v12, v12, v93
    v_add_f32 v13, v13, v85
    v_add_f32 v10, v10, v94
    v_add_f32 v11, v11, v86
    v_add_f32 v12, v12, v95
    v_add_f32 v13, v13, v87
    v_add_f32 v10, v10, v12
    v_add_f32 v11, v11, v13
    s_nop 1
    v_permlane32_swap_b32 v10, v11
    v_add_f32 v10, v10, v11
    v_rcp_f32 v10, v10
    s_nop 0
    v_mov_b32 v11, v10
    s_nop 1
    v_permlane32_swap_b32 v10, v11
    v_mul_f32 v88, v88, v10
    v_mul_f32 v89, v89, v10
    v_mul_f32 v90, v90, v10
    v_mul_f32 v91, v91, v10
    v_mul_f32 v92, v92, v10
    v_mul_f32 v93, v93, v10
    v_mul_f32 v94, v94, v10
    v_mul_f32 v95, v95, v10
    v_mul_f32 v80, v80, v11
    v_mul_f32 v81, v81, v11
    v_mul_f32 v82, v82, v11
    v_mul_f32 v83, v83, v11
    v_mul_f32 v84, v84, v11
    v_mul_f32 v85, v85, v11
    v_mul_f32 v86, v86, v11
    v_mul_f32 v87, v87, v11
    v_cvt_pk_bf16_f32 v48, v88, v89
    v_cvt_pk_bf16_f32 v49, v90, v91
    v_cvt_pk_bf16_f32 v50, v92, v93
    v_cvt_pk_bf16_f32 v51, v94, v95
    v_cvt_pk_bf16_f32 v52, v80, v81
    v_cvt_pk_bf16_f32 v53, v82, v83
    v_cvt_pk_bf16_f32 v54, v84, v85
    v_cvt_pk_bf16_f32 v55, v86, v87
    s_cmp_lg_u32 s33, 0
    s_cbranch_scc1 K_GQD
K_GQS:
    ds_read_b32 v13, v114
    s_waitcnt lgkmcnt(0)
    v_readfirstlane_b32 s38, v13
    s_nop 3
    s_cmp_lt_u32 s38, 1
    s_cbranch_scc1 K_GQS
    ds_read_b128 v[116:119], v112 offset:2048
    ds_read_b128 v[168:171], v112
    ds_read_b128 v[172:175], v112 offset:1024
    v_mov_b32 v192, v48
    v_mov_b32 v193, v49
    v_mov_b32 v194, v50
    v_mov_b32 v195, v51
    v_mov_b32 v196, v52
    v_mov_b32 v197, v53
    v_mov_b32 v198, v54
    v_mov_b32 v199, v55
    v_mov_b32 v200, v56
    v_mov_b32 v201, v57
    v_mov_b32 v202, v58
    v_mov_b32 v203, v59
    v_mov_b32 v204, v60
    v_mov_b32 v205, v61
    v_mov_b32 v206, v62
    v_mov_b32 v207, v63
    s_mov_b32 s33, 2
K_GOS:
    ds_read_b32 v13, v96
    s_waitcnt lgkmcnt(0)
    v_readfirstlane_b32 s38, v13
    s_nop 3
    s_cmp_lt_u32 s38, 2
    s_cbranch_scc1 K_GOS
    s_branch K_GQ
K_GQD:
    v_add_u32 v11, 0x10000, v2
    s_cmp_lt_u32 s25, 2
    s_cbranch_scc1 K_GZS
    v_add_u32 v10, s41, v11
    s_waitcnt vmcnt(0)
    s_mov_b32 s3, 0
V17:
    v_max_u32 v12, v208, v209
    v_max3_u32 v12, v12, v210, v211
    v_max3_u32 v12, v12, v212, v213
    v_max3_u32 v12, v12, v214, v215
    v_max3_u32 v12, v12, v216, v217
    v_max3_u32 v12, v12, v218, v219
    v_max3_u32 v12, v12, v220, v221
    v_max3_u32 v12, v12, v222, v223
    v_cmp_eq_u32 vcc, -1, v12
    s_nop 0
    s_cmp_eq_u64 vcc, 0
    s_cbranch_scc1 V18
    s_sleep 8
    buffer_load_dwordx4 v[208:211], v2, s[16:19], s40 offen offset:0 sc1
    buffer_load_dwordx4 v[212:215], v2, s[16:19], s40 offen offset:1024 sc1
    buffer_load_dwordx4 v[216:219], v2, s[16:19], s40 offen offset:2048 sc1
    buffer_load_dwordx4 v[220:223], v2, s[16:19], s40 offen offset:3072 sc1
    s_add_u32 s3, s3, 1
    s_cmp_lt_u32 s3, 2500
    s_waitcnt vmcnt(0)
    s_cbranch_scc1 V17
V18:
    ds_write_b128 v10, v[208:211] offset:0
    ds_write_b128 v10, v[212:215] offset:1024
    ds_write_b128 v10, v[216:219] offset:2048
    ds_write_b128 v10, v[220:223] offset:3072
    s_waitcnt lgkmcnt(0)
    s_mov_b64 exec, 1
    ds_add_u32 v96, v97
    s_mov_b64 exec, -1
K_GZS:
    ds_read_b32 v13, v96
    s_waitcnt lgkmcnt(0)
    v_readfirstlane_b32 s38, v13
    s_nop 3
    s_cmp_lt_u32 s38, 4
    s_cbranch_scc1 K_GZS
    ds_read_b128 v[208:211], v11 offset:0
    ds_read_b128 v[212:215], v11 offset:1024
    ds_read_b128 v[216:219], v11 offset:2048
    ds_read_b128 v[220:223], v11 offset:3072
    ds_read_b128 v[224:227], v11 offset:4096
    ds_read_b128 v[228:231], v11 offset:5120
    ds_read_b128 v[232:235], v11 offset:6144
    ds_read_b128 v[236:239], v11 offset:7168
    s_lshl_b32 s40, s31, 16
    s_lshl_b32 s38, s27, 13
    s_add_u32 s40, s40, s38
    s_lshl_b32 s38, s26, 12
    s_add_u32 s40, s40, s38
    s_add_u32 s40, s40, 16777216
    s_xor_b32 s41, s40, 4096
    s_lshr_b32 s38, s31, 1
    s_and_b32 s38, s38, 6
    s_and_b32 s62, s31, 1
    s_or_b32 s38, s38, s62
    s_cmp_eq_u32 s38, 3
    s_cselect_b32 s38, 7, s38
    s_lshl_b32 s38, s38, 7
    s_add_u32 s38, s38, 640
    s_mov_b32 s62, 0xff000000
    s_mov_b32 s63, 0
    v_mov_b32 v127, s38
    v_cndmask_b32 v127, 0, v127, s[62:63]
    v_add_u32 v127, v127, v2
    s_and_b32 s38, s31, 1
    s_lshl_b32 s38, s38, 10
    v_xor_b32 v127, s38, v127
    s_waitcnt lgkmcnt(0)
    v_mfma_f32_32x32x16_bf16 v[64:79], v[208:211], v[192:195], 0
    v_mfma_f32_32x32x16_bf16 v[64:79], v[212:215], v[196:199], v[64:79]
    v_mfma_f32_32x32x16_bf16 v[80:95], v[216:219], v[200:203], 0
    v_mfma_f32_32x32x16_bf16 v[80:95], v[220:223], v[204:207], v[80:95]
    v_mfma_f32_32x32x16_bf16 v[128:143], v[224:227], v[48:51], 0
    v_mfma_f32_32x32x16_bf16 v[128:143], v[228:231], v[52:55], v[128:143]
    v_mfma_f32_32x32x16_bf16 v[144:159], v[232:235], v[56:59], 0
    v_mfma_f32_32x32x16_bf16 v[144:159], v[236:239], v[60:63], v[144:159]
    s_nop 5
    v_add_f32 v8, 0x358637bd, v72
    v_rcp_f32 v8, v8
    s_nop 0
    v_mul_f32 v64, v64, v8
    v_mul_f32 v65, v65, v8
    v_mul_f32 v66, v66, v8
    v_mul_f32 v67, v67, v8
    v_mul_f32 v68, v68, v8
    v_mul_f32 v69, v69, v8
    v_mul_f32 v70, v70, v8
    v_mul_f32 v71, v71, v8
    v_cvt_pk_bf16_f32 v32, v64, v65
    v_cvt_pk_bf16_f32 v33, v66, v67
    v_cvt_pk_bf16_f32 v34, v68, v69
    v_cvt_pk_bf16_f32 v35, v70, v71
    buffer_store_dwordx4 v[32:35], v127, s[16:19], s40 offen offset:0 sc1
    v_add_f32 v8, 0x358637bd, v88
    v_rcp_f32 v8, v8
    s_nop 0
    v_mul_f32 v80, v80, v8
    v_mul_f32 v81, v81, v8
    v_mul_f32 v82, v82, v8
    v_mul_f32 v83, v83, v8
    v_mul_f32 v84, v84, v8
    v_mul_f32 v85, v85, v8
    v_mul_f32 v86, v86, v8
    v_mul_f32 v87, v87, v8
    v_cvt_pk_bf16_f32 v36, v80, v81
    v_cvt_pk_bf16_f32 v37, v82, v83
    v_cvt_pk_bf16_f32 v38, v84, v85
    v_cvt_pk_bf16_f32 v39, v86, v87
    buffer_store_dwordx4 v[36:39], v127, s[16:19], s40 offen offset:2048 sc1
    v_add_f32 v8, 0x358637bd, v136
    v_rcp_f32 v8, v8
    s_nop 0
    v_mul_f32 v128, v128, v8
    v_mul_f32 v129, v129, v8
    v_mul_f32 v130, v130, v8
    v_mul_f32 v131, v131, v8
    v_mul_f32 v132, v132, v8
    v_mul_f32 v133, v133, v8
    v_mul_f32 v134, v134, v8
    v_mul_f32 v135, v135, v8
    v_cvt_pk_bf16_f32 v40, v128, v129
    v_cvt_pk_bf16_f32 v41, v130, v131
    v_cvt_pk_bf16_f32 v42, v132, v133
    v_cvt_pk_bf16_f32 v43, v134, v135
    buffer_store_dwordx4 v[40:43], v127, s[16:19], s41 offen offset:0 sc1
    v_add_f32 v8, 0x358637bd, v152
    v_rcp_f32 v8, v8
    s_nop 0
    v_mul_f32 v144, v144, v8
    v_mul_f32 v145, v145, v8
    v_mul_f32 v146, v146, v8
    v_mul_f32 v147, v147, v8
    v_mul_f32 v148, v148, v8
    v_mul_f32 v149, v149, v8
    v_mul_f32 v150, v150, v8
    v_mul_f32 v151, v151, v8
    v_cvt_pk_bf16_f32 v44, v144, v145
    v_cvt_pk_bf16_f32 v45, v146, v147
    v_cvt_pk_bf16_f32 v46, v148, v149
    v_cvt_pk_bf16_f32 v47, v150, v151
    buffer_store_dwordx4 v[44:47], v127, s[16:19], s41 offen offset:2048 sc1
    s_branch K_GFIN
K_P2:
    s_setprio 0
    s_load_dwordx4 s[72:75], s[0:1], 64
    s_lshr_b32 s39, s27, 2
    s_lshl_b32 s40, s28, 1
    s_add_u32 s40, s40, s39
    s_lshr_b32 s39, s32, 2
    s_lshl_b32 s39, s39, 7
    s_lshl_b32 s56, s25, 1
    s_add_u32 s56, s56, s77
    s_lshl_b32 s55, s40, 16
    s_add_u32 s55, s55, s39
    s_lshl_b32 s38, s56, 13
    s_add_u32 s55, s55, s38
    buffer_load_dwordx4 v[32:35], v6, s[8:11], s55 offen
    v_and_b32 v229, 0x70, v2
    s_waitcnt lgkmcnt(0)
    s_mov_b32 s68, s72
    s_mov_b32 s69, s73
    s_mov_b32 s70, 0x400
    s_mov_b32 s71, 0x00020000
    s_mov_b32 s64, s74
    s_mov_b32 s65, s75
    s_mov_b32 s66, 0x200000
    s_mov_b32 s67, 0x00020000
    buffer_load_dwordx4 v[40:43], v229, s[68:71], s39 offen
    s_lshl_b32 s51, s40, 17
    s_lshl_b32 s38, s25, 14
    s_add_u32 s51, s51, s38
    s_add_u32 s51, s51, 16777216
    s_add_u32 s53, s51, 65536
    v_bfe_u32 v230, v1, 2, 2
    v_lshrrev_b32 v228, 5, v1
    v_bfe_u32 v227, v1, 4, 1
    v_lshl_add_u32 v231, v228, 2, v230
    v_lshlrev_b32 v4, 7, v231
    v_lshl_add_u32 v4, v227, 5, v4
    v_and_b32 v231, 3, v1
    v_lshl_add_u32 v4, v231, 3, v4
    v_lshrrev_b32 v230, 1, v230
    v_lshl_add_u32 v4, v230, 6, v4
    v_add_u32 v4, s34, v4
    v_xor_b32 v5, 64, v4
    v_add_u32 v232, 0x0, v4
    v_add_u32 v233, 0x0, v5
    v_add_u32 v234, 0x10000, v4
    v_add_u32 v235, 0x10000, v5
    v_add_u32 v236, 0x20000, v4
    v_add_u32 v237, 0x20000, v5
    s_waitcnt vmcnt(28)
    ds_read_b64_tr_b16 v[112:113], v234 offset:16384
    ds_read_b64_tr_b16 v[114:115], v234 offset:17408
    ds_read_b64_tr_b16 v[116:117], v235 offset:16384
    ds_read_b64_tr_b16 v[118:119], v235 offset:17408
    s_waitcnt lgkmcnt(0)
    v_mfma_f32_32x32x16_bf16 v[48:63], v[112:115], v[128:131], 0
    v_mfma_f32_32x32x16_bf16 v[64:79], v[112:115], v[132:135], 0
    s_waitcnt vmcnt(26)
    ds_read_b64_tr_b16 v[120:121], v234 offset:24576
    ds_read_b64_tr_b16 v[122:123], v234 offset:25600
    ds_read_b64_tr_b16 v[124:125], v235 offset:24576
    ds_read_b64_tr_b16 v[126:127], v235 offset:25600
    v_mfma_f32_32x32x16_bf16 v[80:95], v[116:119], v[128:131], 0
    v_mfma_f32_32x32x16_bf16 v[96:111], v[116:119], v[132:135], 0
    s_waitcnt lgkmcnt(0)
    v_mfma_f32_32x32x16_bf16 v[48:63], v[120:123], v[136:139], v[48:63]
    v_mfma_f32_32x32x16_bf16 v[64:79], v[120:123], v[140:143], v[64:79]
    s_waitcnt vmcnt(24)
    ds_read_b64_tr_b16 v[112:113], v234 offset:49152
    ds_read_b64_tr_b16 v[114:115], v234 offset:50176
    ds_read_b64_tr_b16 v[116:117], v235 offset:49152
    ds_read_b64_tr_b16 v[118:119], v235 offset:50176
    v_mfma_f32_32x32x16_bf16 v[80:95], v[124:127], v[136:139], v[80:95]
    v_mfma_f32_32x32x16_bf16 v[96:111], v[124:127], v[140:143], v[96:111]
    s_add_u32 m0, s34, 81920
    s_add_u32 s38, s43, 344064
    buffer_load_dwordx4 v3, s[12:15], s38 offen lds
    s_add_u32 m0, s34, 82944
    s_add_u32 s38, s43, 352256
    buffer_load_dwordx4 v3, s[12:15], s38 offen lds
    s_waitcnt lgkmcnt(0)
    v_mfma_f32_32x32x16_bf16 v[48:63], v[112:115], v[144:147], v[48:63]
    v_mfma_f32_32x32x16_bf16 v[64:79], v[112:115], v[148:151], v[64:79]
    s_waitcnt vmcnt(24)
    ds_read_b64_tr_b16 v[120:121], v234 offset:57344
    ds_read_b64_tr_b16 v[122:123], v234 offset:58368
    ds_read_b64_tr_b16 v[124:125], v235 offset:57344
    ds_read_b64_tr_b16 v[126:127], v235 offset:58368
    v_mfma_f32_32x32x16_bf16 v[80:95], v[116:119], v[144:147], v[80:95]
    v_mfma_f32_32x32x16_bf16 v[96:111], v[116:119], v[148:151], v[96:111]
    s_add_u32 m0, s34, 90112
    s_add_u32 s38, s43, 360448
    buffer_load_dwordx4 v3, s[12:15], s38 offen lds
    s_add_u32 m0, s34, 91136
    s_add_u32 s38, s43, 368640
    buffer_load_dwordx4 v3, s[12:15], s38 offen lds
    s_waitcnt lgkmcnt(0)
    v_mfma_f32_32x32x16_bf16 v[48:63], v[120:123], v[152:155], v[48:63]
    v_mfma_f32_32x32x16_bf16 v[64:79], v[120:123], v[156:159], v[64:79]
    s_waitcnt vmcnt(24)
    ds_read_b64_tr_b16 v[112:113], v236 offset:8192
    ds_read_b64_tr_b16 v[114:115], v236 offset:9216
    ds_read_b64_tr_b16 v[116:117], v237 offset:8192
    ds_read_b64_tr_b16 v[118:119], v237 offset:9216
    v_mfma_f32_32x32x16_bf16 v[80:95], v[124:127], v[152:155], v[80:95]
    v_mfma_f32_32x32x16_bf16 v[96:111], v[124:127], v[156:159], v[96:111]
    s_add_u32 m0, s34, 114688
    s_add_u32 s38, s43, 376832
    buffer_load_dwordx4 v3, s[12:15], s38 offen lds
    s_add_u32 m0, s34, 115712
    s_add_u32 s38, s43, 385024
    buffer_load_dwordx4 v3, s[12:15], s38 offen lds
    s_waitcnt lgkmcnt(0)
    v_mfma_f32_32x32x16_bf16 v[48:63], v[112:115], v[160:163], v[48:63]
    v_mfma_f32_32x32x16_bf16 v[64:79], v[112:115], v[164:167], v[64:79]
    s_waitcnt vmcnt(24)
    ds_read_b64_tr_b16 v[120:121], v236 offset:16384
    ds_read_b64_tr_b16 v[122:123], v236 offset:17408
    ds_read_b64_tr_b16 v[124:125], v237 offset:16384
    ds_read_b64_tr_b16 v[126:127], v237 offset:17408
    v_mfma_f32_32x32x16_bf16 v[80:95], v[116:119], v[160:163], v[80:95]
    v_mfma_f32_32x32x16_bf16 v[96:111], v[116:119], v[164:167], v[96:111]
    s_add_u32 m0, s34, 122880
    s_add_u32 s38, s43, 131072
    buffer_load_dwordx4 v3, s[12:15], s38 offen lds
    s_add_u32 m0, s34, 123904
    s_add_u32 s38, s43, 139264
    buffer_load_dwordx4 v3, s[12:15], s38 offen lds
    s_waitcnt lgkmcnt(0)
    v_mfma_f32_32x32x16_bf16 v[48:63], v[120:123], v[168:171], v[48:63]
    v_mfma_f32_32x32x16_bf16 v[64:79], v[120:123], v[172:175], v[64:79]
    s_waitcnt vmcnt(24)
    ds_read_b64_tr_b16 v[112:113], v236 offset:24576
    ds_read_b64_tr_b16 v[114:115], v236 offset:25600
    ds_read_b64_tr_b16 v[116:117], v237 offset:24576
    ds_read_b64_tr_b16 v[118:119], v237 offset:25600
    v_mfma_f32_32x32x16_bf16 v[80:95], v[124:127], v[168:171], v[80:95]
    v_mfma_f32_32x32x16_bf16 v[96:111], v[124:127], v[172:175], v[96:111]
    s_add_u32 m0, s34, 139264
    s_add_u32 s38, s43, 147456
    buffer_load_dwordx4 v3, s[12:15], s38 offen lds
    s_add_u32 m0, s34, 140288
    s_add_u32 s38, s43, 155648
    buffer_load_dwordx4 v3, s[12:15], s38 offen lds
    s_waitcnt lgkmcnt(0)
    v_mfma_f32_32x32x16_bf16 v[48:63], v[112:115], v[176:179], v[48:63]
    s_add_u32 s41, s30, 40960
    s_add_u32 s42, s33, 40960
    buffer_load_dwordx4 v[128:131], v238, s[16:19], s41 offen offset:0 sc1
    buffer_load_dwordx4 v[132:135], v239, s[16:19], s42 offen offset:0 sc1
    v_mfma_f32_32x32x16_bf16 v[64:79], v[112:115], v[180:183], v[64:79]
    s_waitcnt vmcnt(26)
    ds_read_b64_tr_b16 v[120:121], v232 offset:0
    ds_read_b64_tr_b16 v[122:123], v232 offset:1024
    ds_read_b64_tr_b16 v[124:125], v233 offset:0
    ds_read_b64_tr_b16 v[126:127], v233 offset:1024
    v_mfma_f32_32x32x16_bf16 v[80:95], v[116:119], v[176:179], v[80:95]
    v_mfma_f32_32x32x16_bf16 v[96:111], v[116:119], v[180:183], v[96:111]
    s_add_u32 m0, s34, 147456
    s_add_u32 s38, s43, 163840
    buffer_load_dwordx4 v3, s[12:15], s38 offen lds
    s_add_u32 m0, s34, 148480
    s_add_u32 s38, s43, 172032
    buffer_load_dwordx4 v3, s[12:15], s38 offen lds
    s_waitcnt lgkmcnt(0)
    v_mfma_f32_32x32x16_bf16 v[48:63], v[120:123], v[184:187], v[48:63]
    buffer_load_dwordx4 v[136:139], v238, s[16:19], s41 offen offset:2048 sc1
    buffer_load_dwordx4 v[140:143], v239, s[16:19], s42 offen offset:2048 sc1
    v_mfma_f32_32x32x16_bf16 v[64:79], v[120:123], v[188:191], v[64:79]
    s_waitcnt vmcnt(28)
    ds_read_b64_tr_b16 v[112:113], v232 offset:8192
    ds_read_b64_tr_b16 v[114:115], v232 offset:9216
    ds_read_b64_tr_b16 v[116:117], v233 offset:8192
    ds_read_b64_tr_b16 v[118:119], v233 offset:9216
    v_mfma_f32_32x32x16_bf16 v[80:95], v[124:127], v[184:187], v[80:95]
    v_max3_u32 v224, v192, v193, v194
    v_max3_u32 v225, v195, v196, v197
    v_max3_u32 v224, v224, v198, v199
    v_max_u32 v224, v224, v225
    v_cmp_eq_u32 vcc, -1, v224
    s_nop 0
    s_cmp_lg_u64 vcc, 0
    s_cbranch_scc1 K_RT8
K_RB8:
    v_mfma_f32_32x32x16_bf16 v[96:111], v[124:127], v[188:191], v[96:111]
    s_add_u32 m0, s34, 155648
    s_add_u32 s38, s43, 180224
    buffer_load_dwordx4 v3, s[12:15], s38 offen lds
    s_add_u32 m0, s34, 156672
    s_add_u32 s38, s43, 188416
    buffer_load_dwordx4 v3, s[12:15], s38 offen lds
    s_waitcnt lgkmcnt(0)
    v_mfma_f32_32x32x16_bf16 v[48:63], v[112:115], v[192:195], v[48:63]
    s_add_u32 s41, s30, 45056
    s_add_u32 s42, s33, 45056
    buffer_load_dwordx4 v[144:147], v238, s[16:19], s41 offen offset:0 sc1
    buffer_load_dwordx4 v[148:151], v239, s[16:19], s42 offen offset:0 sc1
    v_mfma_f32_32x32x16_bf16 v[64:79], v[112:115], v[196:199], v[64:79]
    s_waitcnt vmcnt(30)
    ds_read_b64_tr_b16 v[120:121], v232 offset:16384
    ds_read_b64_tr_b16 v[122:123], v232 offset:17408
    ds_read_b64_tr_b16 v[124:125], v233 offset:16384
    ds_read_b64_tr_b16 v[126:127], v233 offset:17408
    v_mfma_f32_32x32x16_bf16 v[80:95], v[116:119], v[192:195], v[80:95]
    v_max3_u32 v224, v200, v201, v202
    v_max3_u32 v225, v203, v204, v205
    v_max3_u32 v224, v224, v206, v207
    v_max_u32 v224, v224, v225
    v_cmp_eq_u32 vcc, -1, v224
    s_nop 0
    s_cmp_lg_u64 vcc, 0
    s_cbranch_scc1 K_RT9
K_RB9:
    v_mfma_f32_32x32x16_bf16 v[96:111], v[116:119], v[196:199], v[96:111]
    s_add_u32 m0, s34, 0
    s_add_u32 s38, s43, 393216
    buffer_load_dwordx4 v3, s[12:15], s38 offen lds
    s_add_u32 m0, s34, 1024
    s_add_u32 s38, s43, 401408
    buffer_load_dwordx4 v3, s[12:15], s38 offen lds
    s_waitcnt lgkmcnt(0)
    v_mfma_f32_32x32x16_bf16 v[48:63], v[120:123], v[200:203], v[48:63]
    buffer_load_dwordx4 v[152:155], v238, s[16:19], s41 offen offset:2048 sc1
    buffer_load_dwordx4 v[156:159], v239, s[16:19], s42 offen offset:2048 sc1
    v_mfma_f32_32x32x16_bf16 v[64:79], v[120:123], v[204:207], v[64:79]
    s_waitcnt vmcnt(32)
    ds_read_b64_tr_b16 v[112:113], v232 offset:24576
    ds_read_b64_tr_b16 v[114:115], v232 offset:25600
    ds_read_b64_tr_b16 v[116:117], v233 offset:24576
    ds_read_b64_tr_b16 v[118:119], v233 offset:25600
    v_mfma_f32_32x32x16_bf16 v[80:95], v[124:127], v[200:203], v[80:95]
    v_max3_u32 v224, v208, v209, v210
    v_max3_u32 v225, v211, v212, v213
    v_max3_u32 v224, v224, v214, v215
    v_max_u32 v224, v224, v225
    v_cmp_eq_u32 vcc, -1, v224
    s_nop 0
    s_cmp_lg_u64 vcc, 0
    s_cbranch_scc1 K_RT10
K_RB10:
    v_mfma_f32_32x32x16_bf16 v[96:111], v[124:127], v[204:207], v[96:111]
    s_add_u32 m0, s34, 8192
    s_add_u32 s38, s43, 409600
    buffer_load_dwordx4 v3, s[12:15], s38 offen lds
    s_add_u32 m0, s34, 9216
    s_add_u32 s38, s43, 417792
    buffer_load_dwordx4 v3, s[12:15], s38 offen lds
    s_waitcnt lgkmcnt(0)
    v_mfma_f32_32x32x16_bf16 v[48:63], v[112:115], v[208:211], v[48:63]
    v_mfma_f32_32x32x16_bf16 v[64:79], v[112:115], v[212:215], v[64:79]
    s_waitcnt vmcnt(30)
    ds_read_b64_tr_b16 v[120:121], v232 offset:32768
    ds_read_b64_tr_b16 v[122:123], v232 offset:33792
    ds_read_b64_tr_b16 v[124:125], v233 offset:32768
    ds_read_b64_tr_b16 v[126:127], v233 offset:33792
    v_mfma_f32_32x32x16_bf16 v[80:95], v[116:119], v[208:211], v[80:95]
    v_max3_u32 v224, v216, v217, v218
    v_max3_u32 v225, v219, v220, v221
    v_max3_u32 v224, v224, v222, v223
    v_max_u32 v224, v224, v225
    v_cmp_eq_u32 vcc, -1, v224
    s_nop 0
    s_cmp_lg_u64 vcc, 0
    s_cbranch_scc1 K_RT11
K_RB11:
    v_mfma_f32_32x32x16_bf16 v[96:111], v[116:119], v[212:215], v[96:111]
    s_add_u32 m0, s34, 16384
    s_add_u32 s38, s43, 425984
    buffer_load_dwordx4 v3, s[12:15], s38 offen lds
    s_add_u32 m0, s34, 17408
    s_add_u32 s38, s43, 434176
    buffer_load_dwordx4 v3, s[12:15], s38 offen lds
    s_waitcnt lgkmcnt(0)
    v_mfma_f32_32x32x16_bf16 v[48:63], v[120:123], v[216:219], v[48:63]
    v_mfma_f32_32x32x16_bf16 v[64:79], v[120:123], v[220:223], v[64:79]
    s_waitcnt vmcnt(16)
    ds_read_b64_tr_b16 v[112:113], v232 offset:40960
    ds_read_b64_tr_b16 v[114:115], v232 offset:41984
    ds_read_b64_tr_b16 v[116:117], v233 offset:40960
    ds_read_b64_tr_b16 v[118:119], v233 offset:41984
    v_mfma_f32_32x32x16_bf16 v[80:95], v[124:127], v[216:219], v[80:95]
    v_max3_u32 v224, v128, v129, v130
    v_max3_u32 v225, v131, v132, v133
    v_max3_u32 v224, v224, v134, v135
    v_max_u32 v224, v224, v225
    v_cmp_eq_u32 vcc, -1, v224
    s_nop 0
    s_cmp_lg_u64 vcc, 0
    s_cbranch_scc1 K_RT12
K_RB12:
    v_mfma_f32_32x32x16_bf16 v[96:111], v[124:127], v[220:223], v[96:111]
    s_add_u32 m0, s34, 24576
    s_add_u32 s38, s43, 442368
    buffer_load_dwordx4 v3, s[12:15], s38 offen lds
    s_add_u32 m0, s34, 25600
    s_add_u32 s38, s43, 450560
    buffer_load_dwordx4 v3, s[12:15], s38 offen lds
    s_waitcnt lgkmcnt(0)
    v_mfma_f32_32x32x16_bf16 v[48:63], v[112:115], v[128:131], v[48:63]
    s_add_u32 s41, s30, 16384
    s_add_u32 s42, s33, 16384
    buffer_load_dwordx4 v[160:163], v238, s[16:19], s41 offen offset:0 sc1
    buffer_load_dwordx4 v[164:167], v239, s[16:19], s42 offen offset:0 sc1
    v_mfma_f32_32x32x16_bf16 v[64:79], v[112:115], v[132:135], v[64:79]
    s_waitcnt vmcnt(16)
    ds_read_b64_tr_b16 v[120:121], v234 offset:16384
    ds_read_b64_tr_b16 v[122:123], v234 offset:17408
    ds_read_b64_tr_b16 v[124:125], v235 offset:16384
    ds_read_b64_tr_b16 v[126:127], v235 offset:17408
    v_mfma_f32_32x32x16_bf16 v[80:95], v[116:119], v[128:131], v[80:95]
    v_max3_u32 v224, v136, v137, v138
    v_max3_u32 v225, v139, v140, v141
    v_max3_u32 v224, v224, v142, v143
    v_max_u32 v224, v224, v225
    v_cmp_eq_u32 vcc, -1, v224
    s_nop 0
    s_cmp_lg_u64 vcc, 0
    s_cbranch_scc1 K_RT13
K_RB13:
    v_mfma_f32_32x32x16_bf16 v[96:111], v[116:119], v[132:135], v[96:111]
    s_add_u32 m0, s34, 32768
    s_add_u32 s38, s43, 196608
    buffer_load_dwordx4 v3, s[12:15], s38 offen lds
    s_add_u32 m0, s34, 33792
    s_add_u32 s38, s43, 204800
    buffer_load_dwordx4 v3, s[12:15], s38 offen lds
    v_lshlrev_b32 v26, 16, v40
    v_and_b32 v27, s37, v40
    v_lshlrev_b32 v16, 16, v32
    s_waitcnt lgkmcnt(0)
    v_mfma_f32_32x32x16_bf16 v[48:63], v[120:123], v[136:139], v[48:63]
    buffer_load_dwordx4 v[168:171], v238, s[16:19], s41 offen offset:2048 sc1
    buffer_load_dwordx4 v[172:175], v239, s[16:19], s42 offen offset:2048 sc1
    v_mfma_f32_32x32x16_bf16 v[64:79], v[120:123], v[140:143], v[64:79]
    s_waitcnt vmcnt(16)
    ds_read_b64_tr_b16 v[112:113], v234 offset:24576
    ds_read_b64_tr_b16 v[114:115], v234 offset:25600
    ds_read_b64_tr_b16 v[116:117], v235 offset:24576
    ds_read_b64_tr_b16 v[118:119], v235 offset:25600
    v_mfma_f32_32x32x16_bf16 v[80:95], v[124:127], v[136:139], v[80:95]
    v_max3_u32 v224, v144, v145, v146
    v_max3_u32 v225, v147, v148, v149
    v_max3_u32 v224, v224, v150, v151
    v_max_u32 v224, v224, v225
    v_cmp_eq_u32 vcc, -1, v224
    s_nop 0
    s_cmp_lg_u64 vcc, 0
    s_cbranch_scc1 K_RT14
K_RB14:
    v_mfma_f32_32x32x16_bf16 v[96:111], v[124:127], v[140:143], v[96:111]
    s_add_u32 m0, s34, 40960
    s_add_u32 s38, s43, 212992
    buffer_load_dwordx4 v3, s[12:15], s38 offen lds
    s_add_u32 m0, s34, 41984
    s_add_u32 s38, s43, 221184
    buffer_load_dwordx4 v3, s[12:15], s38 offen lds
    v_and_b32 v17, s37, v32
    v_add_f32 v16, v16, v26
    v_add_f32 v17, v17, v27
    s_waitcnt lgkmcnt(0)
    v_mfma_f32_32x32x16_bf16 v[48:63], v[112:115], v[144:147], v[48:63]
    s_add_u32 s41, s30, 20480
    s_add_u32 s42, s33, 20480
    buffer_load_dwordx4 v[176:179], v238, s[16:19], s41 offen offset:0 sc1
    buffer_load_dwordx4 v[180:183], v239, s[16:19], s42 offen offset:0 sc1
    v_mfma_f32_32x32x16_bf16 v[64:79], v[112:115], v[148:151], v[64:79]
    s_waitcnt vmcnt(16)
    ds_read_b64_tr_b16 v[120:121], v234 offset:49152
    ds_read_b64_tr_b16 v[122:123], v234 offset:50176
    ds_read_b64_tr_b16 v[124:125], v235 offset:49152
    ds_read_b64_tr_b16 v[126:127], v235 offset:50176
    v_mfma_f32_32x32x16_bf16 v[80:95], v[116:119], v[144:147], v[80:95]
    v_max3_u32 v224, v152, v153, v154
    v_max3_u32 v225, v155, v156, v157
    v_max3_u32 v224, v224, v158, v159
    v_max_u32 v224, v224, v225
    v_cmp_eq_u32 vcc, -1, v224
    s_nop 0
    s_cmp_lg_u64 vcc, 0
    s_cbranch_scc1 K_RT15
K_RB15:
    v_mfma_f32_32x32x16_bf16 v[96:111], v[116:119], v[148:151], v[96:111]
    s_add_u32 m0, s34, 81920
    s_add_u32 s38, s43, 229376
    buffer_load_dwordx4 v3, s[12:15], s38 offen lds
    s_add_u32 m0, s34, 82944
    s_add_u32 s38, s43, 237568
    buffer_load_dwordx4 v3, s[12:15], s38 offen lds
    v_lshlrev_b32 v26, 16, v41
    v_and_b32 v27, s37, v41
    v_lshlrev_b32 v18, 16, v33
    s_waitcnt lgkmcnt(0)
    v_mfma_f32_32x32x16_bf16 v[48:63], v[120:123], v[152:155], v[48:63]
    buffer_load_dwordx4 v[184:187], v238, s[16:19], s41 offen offset:2048 sc1
    buffer_load_dwordx4 v[188:191], v239, s[16:19], s42 offen offset:2048 sc1
    v_mfma_f32_32x32x16_bf16 v[64:79], v[120:123], v[156:159], v[64:79]
    s_waitcnt vmcnt(12)
    ds_read_b64_tr_b16 v[112:113], v234 offset:57344
    ds_read_b64_tr_b16 v[114:115], v234 offset:58368
    ds_read_b64_tr_b16 v[116:117], v235 offset:57344
    ds_read_b64_tr_b16 v[118:119], v235 offset:58368
    v_mfma_f32_32x32x16_bf16 v[80:95], v[124:127], v[152:155], v[80:95]
    v_max3_u32 v224, v160, v161, v162
    v_max3_u32 v225, v163, v164, v165
    v_max3_u32 v224, v224, v166, v167
    v_max_u32 v224, v224, v225
    v_cmp_eq_u32 vcc, -1, v224
    s_nop 0
    s_cmp_lg_u64 vcc, 0
    s_cbranch_scc1 K_RT16
K_RB16:
    v_mfma_f32_32x32x16_bf16 v[96:111], v[124:127], v[156:159], v[96:111]
    s_add_u32 m0, s34, 90112
    s_add_u32 s38, s43, 245760
    buffer_load_dwordx4 v3, s[12:15], s38 offen lds
    s_add_u32 m0, s34, 91136
    s_add_u32 s38, s43, 253952
    buffer_load_dwordx4 v3, s[12:15], s38 offen lds
    v_and_b32 v19, s37, v33
    v_add_f32 v18, v18, v26
    v_add_f32 v19, v19, v27
    s_waitcnt lgkmcnt(0)
    v_mfma_f32_32x32x16_bf16 v[48:63], v[112:115], v[160:163], v[48:63]
    s_add_u32 s41, s30, 49152
    s_add_u32 s42, s33, 49152
    buffer_load_dwordx4 v[192:195], v238, s[16:19], s41 offen offset:0 sc1
    buffer_load_dwordx4 v[196:199], v239, s[16:19], s42 offen offset:0 sc1
    v_mfma_f32_32x32x16_bf16 v[64:79], v[112:115], v[164:167], v[64:79]
    s_waitcnt vmcnt(12)
    ds_read_b64_tr_b16 v[120:121], v236 offset:8192
    ds_read_b64_tr_b16 v[122:123], v236 offset:9216
    ds_read_b64_tr_b16 v[124:125], v237 offset:8192
    ds_read_b64_tr_b16 v[126:127], v237 offset:9216
    v_mfma_f32_32x32x16_bf16 v[80:95], v[116:119], v[160:163], v[80:95]
    v_max3_u32 v224, v168, v169, v170
    v_max3_u32 v225, v171, v172, v173
    v_max3_u32 v224, v224, v174, v175
    v_max_u32 v224, v224, v225
    v_cmp_eq_u32 vcc, -1, v224
    s_nop 0
    s_cmp_lg_u64 vcc, 0
    s_cbranch_scc1 K_RT17
K_RB17:
    v_mfma_f32_32x32x16_bf16 v[96:111], v[116:119], v[164:167], v[96:111]
    s_add_u32 m0, s34, 114688
    s_add_u32 s38, s54, 0
    buffer_load_dwordx4 v3, s[20:23], s38 offen lds
    s_add_u32 m0, s34, 115712
    s_add_u32 s38, s54, 8192
    buffer_load_dwordx4 v3, s[20:23], s38 offen lds
    v_lshlrev_b32 v26, 16, v42
    v_and_b32 v27, s37, v42
    v_lshlrev_b32 v20, 16, v34
    s_waitcnt lgkmcnt(0)
    v_mfma_f32_32x32x16_bf16 v[48:63], v[120:123], v[168:171], v[48:63]
    buffer_load_dwordx4 v[200:203], v238, s[16:19], s41 offen offset:2048 sc1
    buffer_load_dwordx4 v[204:207], v239, s[16:19], s42 offen offset:2048 sc1
    v_mfma_f32_32x32x16_bf16 v[64:79], v[120:123], v[172:175], v[64:79]
    s_waitcnt vmcnt(12)
    ds_read_b64_tr_b16 v[112:113], v236 offset:16384
    ds_read_b64_tr_b16 v[114:115], v236 offset:17408
    ds_read_b64_tr_b16 v[116:117], v237 offset:16384
    ds_read_b64_tr_b16 v[118:119], v237 offset:17408
    v_mfma_f32_32x32x16_bf16 v[80:95], v[124:127], v[168:171], v[80:95]
    v_max3_u32 v224, v176, v177, v178
    v_max3_u32 v225, v179, v180, v181
    v_max3_u32 v224, v224, v182, v183
    v_max_u32 v224, v224, v225
    v_cmp_eq_u32 vcc, -1, v224
    s_nop 0
    s_cmp_lg_u64 vcc, 0
    s_cbranch_scc1 K_RT18
K_RB18:
    v_mfma_f32_32x32x16_bf16 v[96:111], v[124:127], v[172:175], v[96:111]
    s_add_u32 m0, s34, 122880
    s_add_u32 s38, s54, 16384
    buffer_load_dwordx4 v3, s[20:23], s38 offen lds
    s_add_u32 m0, s34, 123904
    s_add_u32 s38, s54, 24576
    buffer_load_dwordx4 v3, s[20:23], s38 offen lds
    v_and_b32 v21, s37, v34
    v_add_f32 v20, v20, v26
    v_add_f32 v21, v21, v27
    s_waitcnt lgkmcnt(0)
    v_mfma_f32_32x32x16_bf16 v[48:63], v[112:115], v[176:179], v[48:63]
    s_add_u32 s41, s30, 53248
    s_add_u32 s42, s33, 53248
    buffer_load_dwordx4 v[208:211], v238, s[16:19], s41 offen offset:0 sc1
    buffer_load_dwordx4 v[212:215], v239, s[16:19], s42 offen offset:0 sc1
    v_mfma_f32_32x32x16_bf16 v[64:79], v[112:115], v[180:183], v[64:79]
    s_waitcnt vmcnt(12)
    ds_read_b64_tr_b16 v[120:121], v236 offset:24576
    ds_read_b64_tr_b16 v[122:123], v236 offset:25600
    ds_read_b64_tr_b16 v[124:125], v237 offset:24576
    ds_read_b64_tr_b16 v[126:127], v237 offset:25600
    v_mfma_f32_32x32x16_bf16 v[80:95], v[116:119], v[176:179], v[80:95]
    v_max3_u32 v224, v184, v185, v186
    v_max3_u32 v225, v187, v188, v189
    v_max3_u32 v224, v224, v190, v191
    v_max_u32 v224, v224, v225
    v_cmp_eq_u32 vcc, -1, v224
    s_nop 0
    s_cmp_lg_u64 vcc, 0
    s_cbranch_scc1 K_RT19
K_RB19:
    v_mfma_f32_32x32x16_bf16 v[96:111], v[116:119], v[180:183], v[96:111]
    s_add_u32 m0, s34, 139264
    s_add_u32 s38, s54, 32768
    buffer_load_dwordx4 v3, s[20:23], s38 offen lds
    s_add_u32 m0, s34, 140288
    s_add_u32 s38, s54, 40960
    buffer_load_dwordx4 v3, s[20:23], s38 offen lds
    v_lshlrev_b32 v26, 16, v43
    v_and_b32 v27, s37, v43
    v_lshlrev_b32 v22, 16, v35
    s_waitcnt lgkmcnt(0)
    v_mfma_f32_32x32x16_bf16 v[48:63], v[120:123], v[184:187], v[48:63]
    buffer_load_dwordx4 v[216:219], v238, s[16:19], s41 offen offset:2048 sc1
    buffer_load_dwordx4 v[220:223], v239, s[16:19], s42 offen offset:2048 sc1
    v_mfma_f32_32x32x16_bf16 v[64:79], v[120:123], v[188:191], v[64:79]
    s_waitcnt vmcnt(12)
    ds_read_b64_tr_b16 v[112:113], v232 offset:0
    ds_read_b64_tr_b16 v[114:115], v232 offset:1024
    ds_read_b64_tr_b16 v[116:117], v233 offset:0
    ds_read_b64_tr_b16 v[118:119], v233 offset:1024
    v_mfma_f32_32x32x16_bf16 v[80:95], v[124:127], v[184:187], v[80:95]
    v_max3_u32 v224, v192, v193, v194
    v_max3_u32 v225, v195, v196, v197
    v_max3_u32 v224, v224, v198, v199
    v_max_u32 v224, v224, v225
    v_cmp_eq_u32 vcc, -1, v224
    s_nop 0
    s_cmp_lg_u64 vcc, 0
    s_cbranch_scc1 K_RT20
K_RB20:
    v_mfma_f32_32x32x16_bf16 v[96:111], v[124:127], v[188:191], v[96:111]
    s_add_u32 m0, s34, 147456
    s_add_u32 s38, s54, 49152
    buffer_load_dwordx4 v3, s[20:23], s38 offen lds
    s_add_u32 m0, s34, 148480
    s_add_u32 s38, s54, 57344
    buffer_load_dwordx4 v3, s[20:23], s38 offen lds
    v_and_b32 v23, s37, v35
    v_add_f32 v22, v22, v26
    v_add_f32 v23, v23, v27
    s_waitcnt lgkmcnt(0)
    v_mfma_f32_32x32x16_bf16 v[48:63], v[112:115], v[192:195], v[48:63]
    s_add_u32 s41, s30, 24576
    s_add_u32 s42, s33, 24576
    buffer_load_dwordx4 v[128:131], v238, s[16:19], s41 offen offset:0 sc1
    buffer_load_dwordx4 v[132:135], v239, s[16:19], s42 offen offset:0 sc1
    v_mfma_f32_32x32x16_bf16 v[64:79], v[112:115], v[196:199], v[64:79]
    s_waitcnt vmcnt(12)
    ds_read_b64_tr_b16 v[120:121], v232 offset:8192
    ds_read_b64_tr_b16 v[122:123], v232 offset:9216
    ds_read_b64_tr_b16 v[124:125], v233 offset:8192
    ds_read_b64_tr_b16 v[126:127], v233 offset:9216
    v_mfma_f32_32x32x16_bf16 v[80:95], v[116:119], v[192:195], v[80:95]
    v_max3_u32 v224, v200, v201, v202
    v_max3_u32 v225, v203, v204, v205
    v_max3_u32 v224, v224, v206, v207
    v_max_u32 v224, v224, v225
    v_cmp_eq_u32 vcc, -1, v224
    s_nop 0
    s_cmp_lg_u64 vcc, 0
    s_cbranch_scc1 K_RT21
K_RB21:
    v_mfma_f32_32x32x16_bf16 v[96:111], v[116:119], v[196:199], v[96:111]
    s_add_u32 m0, s34, 155648
    s_add_u32 s38, s54, 65536
    buffer_load_dwordx4 v3, s[20:23], s38 offen lds
    s_add_u32 m0, s34, 156672
    s_add_u32 s38, s54, 73728
    buffer_load_dwordx4 v3, s[20:23], s38 offen lds
    v_lshrrev_b32 v25, 3, v1
    v_mul_u32_u24 v25, 272, v25
    v_and_b32 v26, 7, v1
    s_waitcnt lgkmcnt(0)
    v_mfma_f32_32x32x16_bf16 v[48:63], v[120:123], v[200:203], v[48:63]
    buffer_load_dwordx4 v[136:139], v238, s[16:19], s41 offen offset:2048 sc1
    buffer_load_dwordx4 v[140:143], v239, s[16:19], s42 offen offset:2048 sc1
    v_mfma_f32_32x32x16_bf16 v[64:79], v[120:123], v[204:207], v[64:79]
    s_waitcnt vmcnt(12)
    ds_read_b64_tr_b16 v[112:113], v232 offset:16384
    ds_read_b64_tr_b16 v[114:115], v232 offset:17408
    ds_read_b64_tr_b16 v[116:117], v233 offset:16384
    ds_read_b64_tr_b16 v[118:119], v233 offset:17408
    v_mfma_f32_32x32x16_bf16 v[80:95], v[124:127], v[200:203], v[80:95]
    v_max3_u32 v224, v208, v209, v210
    v_max3_u32 v225, v211, v212, v213
    v_max3_u32 v224, v224, v214, v215
    v_max_u32 v224, v224, v225
    v_cmp_eq_u32 vcc, -1, v224
    s_nop 0
    s_cmp_lg_u64 vcc, 0
    s_cbranch_scc1 K_RT22
K_RB22:
    v_mfma_f32_32x32x16_bf16 v[96:111], v[124:127], v[204:207], v[96:111]
    s_add_u32 m0, s34, 0
    s_add_u32 s38, s54, 81920
    buffer_load_dwordx4 v3, s[20:23], s38 offen lds
    s_add_u32 m0, s34, 1024
    s_add_u32 s38, s54, 90112
    buffer_load_dwordx4 v3, s[20:23], s38 offen lds
    v_lshl_add_u32 v25, v26, 5, v25
    s_mul_i32 s40, s56, 2176
    s_add_u32 s40, s40, 0
    s_waitcnt lgkmcnt(0)
    v_mfma_f32_32x32x16_bf16 v[48:63], v[112:115], v[208:211], v[48:63]
    s_add_u32 s41, s30, 28672
    s_add_u32 s42, s33, 28672
    buffer_load_dwordx4 v[144:147], v238, s[16:19], s41 offen offset:0 sc1
    buffer_load_dwordx4 v[148:151], v239, s[16:19], s42 offen offset:0 sc1
    v_mfma_f32_32x32x16_bf16 v[64:79], v[112:115], v[212:215], v[64:79]
    s_waitcnt vmcnt(12)
    ds_read_b64_tr_b16 v[120:121], v232 offset:24576
    ds_read_b64_tr_b16 v[122:123], v232 offset:25600
    ds_read_b64_tr_b16 v[124:125], v233 offset:24576
    ds_read_b64_tr_b16 v[126:127], v233 offset:25600
    v_mfma_f32_32x32x16_bf16 v[80:95], v[116:119], v[208:211], v[80:95]
    v_max3_u32 v224, v216, v217, v218
    v_max3_u32 v225, v219, v220, v221
    v_max3_u32 v224, v224, v222, v223
    v_max_u32 v224, v224, v225
    v_cmp_eq_u32 vcc, -1, v224
    s_nop 0
    s_cmp_lg_u64 vcc, 0
    s_cbranch_scc1 K_RT23
K_RB23:
    v_mfma_f32_32x32x16_bf16 v[96:111], v[116:119], v[212:215], v[96:111]
    s_add_u32 m0, s34, 8192
    s_add_u32 s38, s54, 98304
    buffer_load_dwordx4 v3, s[20:23], s38 offen lds
    s_add_u32 m0, s34, 9216
    s_add_u32 s38, s54, 106496
    buffer_load_dwordx4 v3, s[20:23], s38 offen lds
    v_add_u32 v25, s40, v25
    v_and_b32 v24, 31, v1
    v_mul_u32_u24 v24, 272, v24
    s_waitcnt lgkmcnt(0)
    v_mfma_f32_32x32x16_bf16 v[48:63], v[120:123], v[216:219], v[48:63]
    buffer_load_dwordx4 v[152:155], v238, s[16:19], s41 offen offset:2048 sc1
    buffer_load_dwordx4 v[156:159], v239, s[16:19], s42 offen offset:2048 sc1
    v_mfma_f32_32x32x16_bf16 v[64:79], v[120:123], v[220:223], v[64:79]
    s_waitcnt vmcnt(12)
    ds_read_b64_tr_b16 v[112:113], v232 offset:32768
    ds_read_b64_tr_b16 v[114:115], v232 offset:33792
    ds_read_b64_tr_b16 v[116:117], v233 offset:32768
    ds_read_b64_tr_b16 v[118:119], v233 offset:33792
    v_mfma_f32_32x32x16_bf16 v[80:95], v[124:127], v[216:219], v[80:95]
    v_max3_u32 v224, v128, v129, v130
    v_max3_u32 v225, v131, v132, v133
    v_max3_u32 v224, v224, v134, v135
    v_max_u32 v224, v224, v225
    v_cmp_eq_u32 vcc, -1, v224
    s_nop 0
    s_cmp_lg_u64 vcc, 0
    s_cbranch_scc1 K_RT24
K_RB24:
    v_mfma_f32_32x32x16_bf16 v[96:111], v[124:127], v[220:223], v[96:111]
    s_add_u32 m0, s34, 16384
    s_add_u32 s38, s54, 114688
    buffer_load_dwordx4 v3, s[20:23], s38 offen lds
    s_add_u32 m0, s34, 17408
    s_add_u32 s38, s54, 122880
    buffer_load_dwordx4 v3, s[20:23], s38 offen lds
    v_lshrrev_b32 v26, 5, v1
    v_lshl_add_u32 v24, v26, 4, v24
    s_mul_i32 s40, s25, 17408
    s_waitcnt lgkmcnt(0)
    v_mfma_f32_32x32x16_bf16 v[48:63], v[112:115], v[128:131], v[48:63]
    s_add_u32 s41, s51, 0
    s_add_u32 s42, s53, 0
    buffer_load_dwordx4 v[160:163], v238, s[16:19], s41 offen offset:0 sc1
    buffer_load_dwordx4 v[164:167], v239, s[16:19], s42 offen offset:0 sc1
    v_mfma_f32_32x32x16_bf16 v[64:79], v[112:115], v[132:135], v[64:79]
    s_waitcnt vmcnt(12)
    ds_read_b64_tr_b16 v[120:121], v232 offset:40960
    ds_read_b64_tr_b16 v[122:123], v232 offset:41984
    ds_read_b64_tr_b16 v[124:125], v233 offset:40960
    ds_read_b64_tr_b16 v[126:127], v233 offset:41984
    v_mfma_f32_32x32x16_bf16 v[80:95], v[116:119], v[128:131], v[80:95]
    v_max3_u32 v224, v136, v137, v138
    v_max3_u32 v225, v139, v140, v141
    v_max3_u32 v224, v224, v142, v143
    v_max_u32 v224, v224, v225
    v_cmp_eq_u32 vcc, -1, v224
    s_nop 0
    s_cmp_lg_u64 vcc, 0
    s_cbranch_scc1 K_RT25
K_RB25:
    v_mfma_f32_32x32x16_bf16 v[96:111], v[116:119], v[132:135], v[96:111]
    s_add_u32 s40, s40, 0
    v_add_u32 v24, s40, v24
    s_waitcnt lgkmcnt(0)
    v_mfma_f32_32x32x16_bf16 v[48:63], v[120:123], v[136:139], v[48:63]
    buffer_load_dwordx4 v[168:171], v238, s[16:19], s41 offen offset:2048 sc1
    buffer_load_dwordx4 v[172:175], v239, s[16:19], s42 offen offset:2048 sc1
    v_mfma_f32_32x32x16_bf16 v[64:79], v[120:123], v[140:143], v[64:79]
    s_waitcnt vmcnt(10)
    ds_read_b64_tr_b16 v[112:113], v234 offset:16384
    ds_read_b64_tr_b16 v[114:115], v234 offset:17408
    ds_read_b64_tr_b16 v[116:117], v235 offset:16384
    ds_read_b64_tr_b16 v[118:119], v235 offset:17408
    v_mfma_f32_32x32x16_bf16 v[80:95], v[124:127], v[136:139], v[80:95]
    v_max3_u32 v224, v144, v145, v146
    v_max3_u32 v225, v147, v148, v149
    v_max3_u32 v224, v224, v150, v151
    v_max_u32 v224, v224, v225
    v_cmp_eq_u32 vcc, -1, v224
    s_nop 0
    s_cmp_lg_u64 vcc, 0
    s_cbranch_scc1 K_RT26
K_RB26:
    v_mfma_f32_32x32x16_bf16 v[96:111], v[124:127], v[140:143], v[96:111]
    s_waitcnt lgkmcnt(0)
    v_mfma_f32_32x32x16_bf16 v[48:63], v[112:115], v[144:147], v[48:63]
    s_add_u32 s41, s51, 4096
    s_add_u32 s42, s53, 4096
    buffer_load_dwordx4 v[176:179], v238, s[16:19], s41 offen offset:0 sc1
    buffer_load_dwordx4 v[180:183], v239, s[16:19], s42 offen offset:0 sc1
    v_mfma_f32_32x32x16_bf16 v[64:79], v[112:115], v[148:151], v[64:79]
    s_waitcnt vmcnt(8)
    ds_read_b64_tr_b16 v[120:121], v234 offset:24576
    ds_read_b64_tr_b16 v[122:123], v234 offset:25600
    ds_read_b64_tr_b16 v[124:125], v235 offset:24576
    ds_read_b64_tr_b16 v[126:127], v235 offset:25600
    v_mfma_f32_32x32x16_bf16 v[80:95], v[116:119], v[144:147], v[80:95]
    v_max3_u32 v224, v152, v153, v154
    v_max3_u32 v225, v155, v156, v157
    v_max3_u32 v224, v224, v158, v159
    v_max_u32 v224, v224, v225
    v_cmp_eq_u32 vcc, -1, v224
    s_nop 0
    s_cmp_lg_u64 vcc, 0
    s_cbranch_scc1 K_RT27
K_RB27:
    v_mfma_f32_32x32x16_bf16 v[96:111], v[116:119], v[148:151], v[96:111]
    s_waitcnt lgkmcnt(0)
    v_mfma_f32_32x32x16_bf16 v[48:63], v[120:123], v[152:155], v[48:63]
    buffer_load_dwordx4 v[184:187], v238, s[16:19], s41 offen offset:2048 sc1
    buffer_load_dwordx4 v[188:191], v239, s[16:19], s42 offen offset:2048 sc1
    v_mfma_f32_32x32x16_bf16 v[64:79], v[120:123], v[156:159], v[64:79]
    s_waitcnt vmcnt(6)
    ds_read_b64_tr_b16 v[112:113], v234 offset:49152
    ds_read_b64_tr_b16 v[114:115], v234 offset:50176
    ds_read_b64_tr_b16 v[116:117], v235 offset:49152
    ds_read_b64_tr_b16 v[118:119], v235 offset:50176
    v_mfma_f32_32x32x16_bf16 v[80:95], v[124:127], v[152:155], v[80:95]
    v_max3_u32 v224, v160, v161, v162
    v_max3_u32 v225, v163, v164, v165
    v_max3_u32 v224, v224, v166, v167
    v_max_u32 v224, v224, v225
    v_cmp_eq_u32 vcc, -1, v224
    s_nop 0
    s_cmp_lg_u64 vcc, 0
    s_cbranch_scc1 K_RT28
K_RB28:
    v_mfma_f32_32x32x16_bf16 v[96:111], v[124:127], v[156:159], v[96:111]
    s_waitcnt lgkmcnt(0)
    v_mfma_f32_32x32x16_bf16 v[48:63], v[112:115], v[160:163], v[48:63]
    s_add_u32 s41, s51, 8192
    s_add_u32 s42, s53, 8192
    buffer_load_dwordx4 v[192:195], v238, s[16:19], s41 offen offset:0 sc1
    buffer_load_dwordx4 v[196:199], v239, s[16:19], s42 offen offset:0 sc1
    v_mfma_f32_32x32x16_bf16 v[64:79], v[112:115], v[164:167], v[64:79]
    s_waitcnt vmcnt(6)
    ds_read_b64_tr_b16 v[120:121], v234 offset:57344
    ds_read_b64_tr_b16 v[122:123], v234 offset:58368
    ds_read_b64_tr_b16 v[124:125], v235 offset:57344
    ds_read_b64_tr_b16 v[126:127], v235 offset:58368
    v_mfma_f32_32x32x16_bf16 v[80:95], v[116:119], v[160:163], v[80:95]
    v_max3_u32 v224, v168, v169, v170
    v_max3_u32 v225, v171, v172, v173
    v_max3_u32 v224, v224, v174, v175
    v_max_u32 v224, v224, v225
    v_cmp_eq_u32 vcc, -1, v224
    s_nop 0
    s_cmp_lg_u64 vcc, 0
    s_cbranch_scc1 K_RT29
K_RB29:
    v_mfma_f32_32x32x16_bf16 v[96:111], v[116:119], v[164:167], v[96:111]
    s_waitcnt lgkmcnt(0)
    v_mfma_f32_32x32x16_bf16 v[48:63], v[120:123], v[168:171], v[48:63]
    buffer_load_dwordx4 v[200:203], v238, s[16:19], s41 offen offset:2048 sc1
    buffer_load_dwordx4 v[204:207], v239, s[16:19], s42 offen offset:2048 sc1
    v_mfma_f32_32x32x16_bf16 v[64:79], v[120:123], v[172:175], v[64:79]
    s_waitcnt vmcnt(6)
    ds_read_b64_tr_b16 v[112:113], v236 offset:8192
    ds_read_b64_tr_b16 v[114:115], v236 offset:9216
    ds_read_b64_tr_b16 v[116:117], v237 offset:8192
    ds_read_b64_tr_b16 v[118:119], v237 offset:9216
    v_mfma_f32_32x32x16_bf16 v[80:95], v[124:127], v[168:171], v[80:95]
    v_max3_u32 v224, v176, v177, v178
    v_max3_u32 v225, v179, v180, v181
    v_max3_u32 v224, v224, v182, v183
    v_max_u32 v224, v224, v225
    v_cmp_eq_u32 vcc, -1, v224
    s_nop 0
    s_cmp_lg_u64 vcc, 0
    s_cbranch_scc1 K_RT30
K_RB30:
    v_mfma_f32_32x32x16_bf16 v[96:111], v[124:127], v[172:175], v[96:111]
    s_waitcnt lgkmcnt(0)
    v_mfma_f32_32x32x16_bf16 v[48:63], v[112:115], v[176:179], v[48:63]
    s_add_u32 s41, s51, 12288
    s_add_u32 s42, s53, 12288
    buffer_load_dwordx4 v[208:211], v238, s[16:19], s41 offen offset:0 sc1
    buffer_load_dwordx4 v[212:215], v239, s[16:19], s42 offen offset:0 sc1
    v_mfma_f32_32x32x16_bf16 v[64:79], v[112:115], v[180:183], v[64:79]
    s_waitcnt vmcnt(6)
    ds_read_b64_tr_b16 v[120:121], v236 offset:16384
    ds_read_b64_tr_b16 v[122:123], v236 offset:17408
    ds_read_b64_tr_b16 v[124:125], v237 offset:16384
    ds_read_b64_tr_b16 v[126:127], v237 offset:17408
    v_mfma_f32_32x32x16_bf16 v[80:95], v[116:119], v[176:179], v[80:95]
    v_max3_u32 v224, v184, v185, v186
    v_max3_u32 v225, v187, v188, v189
    v_max3_u32 v224, v224, v190, v191
    v_max_u32 v224, v224, v225
    v_cmp_eq_u32 vcc, -1, v224
    s_nop 0
    s_cmp_lg_u64 vcc, 0
    s_cbranch_scc1 K_RT31
K_RB31:
    v_mfma_f32_32x32x16_bf16 v[96:111], v[116:119], v[180:183], v[96:111]
    s_waitcnt lgkmcnt(0)
    v_mfma_f32_32x32x16_bf16 v[48:63], v[120:123], v[184:187], v[48:63]
    buffer_load_dwordx4 v[216:219], v238, s[16:19], s41 offen offset:2048 sc1
    buffer_load_dwordx4 v[220:223], v239, s[16:19], s42 offen offset:2048 sc1
    v_mfma_f32_32x32x16_bf16 v[64:79], v[120:123], v[188:191], v[64:79]
    s_waitcnt vmcnt(6)
    ds_read_b64_tr_b16 v[112:113], v236 offset:24576
    ds_read_b64_tr_b16 v[114:115], v236 offset:25600
    ds_read_b64_tr_b16 v[116:117], v237 offset:24576
    ds_read_b64_tr_b16 v[118:119], v237 offset:25600
    v_mfma_f32_32x32x16_bf16 v[80:95], v[124:127], v[184:187], v[80:95]
    v_max3_u32 v224, v192, v193, v194
    v_max3_u32 v225, v195, v196, v197
    v_max3_u32 v224, v224, v198, v199
    v_max_u32 v224, v224, v225
    v_cmp_eq_u32 vcc, -1, v224
    s_nop 0
    s_cmp_lg_u64 vcc, 0
    s_cbranch_scc1 K_RT32
K_RB32:
    v_mfma_f32_32x32x16_bf16 v[96:111], v[124:127], v[188:191], v[96:111]
    s_waitcnt lgkmcnt(0)
    v_mfma_f32_32x32x16_bf16 v[48:63], v[112:115], v[192:195], v[48:63]
    v_mfma_f32_32x32x16_bf16 v[64:79], v[112:115], v[196:199], v[64:79]
    s_waitcnt vmcnt(4)
    ds_read_b64_tr_b16 v[120:121], v232 offset:0
    ds_read_b64_tr_b16 v[122:123], v232 offset:1024
    ds_read_b64_tr_b16 v[124:125], v233 offset:0
    ds_read_b64_tr_b16 v[126:127], v233 offset:1024
    v_mfma_f32_32x32x16_bf16 v[80:95], v[116:119], v[192:195], v[80:95]
    v_max3_u32 v224, v200, v201, v202
    v_max3_u32 v225, v203, v204, v205
    v_max3_u32 v224, v224, v206, v207
    v_max_u32 v224, v224, v225
    v_cmp_eq_u32 vcc, -1, v224
    s_nop 0
    s_cmp_lg_u64 vcc, 0
    s_cbranch_scc1 K_RT33
K_RB33:
    v_mfma_f32_32x32x16_bf16 v[96:111], v[116:119], v[196:199], v[96:111]
    s_waitcnt lgkmcnt(0)
    v_mfma_f32_32x32x16_bf16 v[48:63], v[120:123], v[200:203], v[48:63]
    v_mfma_f32_32x32x16_bf16 v[64:79], v[120:123], v[204:207], v[64:79]
    s_waitcnt vmcnt(2)
    ds_read_b64_tr_b16 v[112:113], v232 offset:8192
    ds_read_b64_tr_b16 v[114:115], v232 offset:9216
    ds_read_b64_tr_b16 v[116:117], v233 offset:8192
    ds_read_b64_tr_b16 v[118:119], v233 offset:9216
    v_mfma_f32_32x32x16_bf16 v[80:95], v[124:127], v[200:203], v[80:95]
    v_max3_u32 v224, v208, v209, v210
    v_max3_u32 v225, v211, v212, v213
    v_max3_u32 v224, v224, v214, v215
    v_max_u32 v224, v224, v225
    v_cmp_eq_u32 vcc, -1, v224
    s_nop 0
    s_cmp_lg_u64 vcc, 0
    s_cbranch_scc1 K_RT34
K_RB34:
    v_mfma_f32_32x32x16_bf16 v[96:111], v[124:127], v[204:207], v[96:111]
    s_waitcnt vmcnt(0)
    ds_read_b64_tr_b16 v[120:121], v232 offset:16384
    ds_read_b64_tr_b16 v[122:123], v232 offset:17408
    ds_read_b64_tr_b16 v[124:125], v233 offset:16384
    ds_read_b64_tr_b16 v[126:127], v233 offset:17408
    v_max3_u32 v224, v216, v217, v218
    v_max3_u32 v225, v219, v220, v221
    v_max3_u32 v224, v224, v222, v223
    v_max_u32 v224, v224, v225
    v_cmp_eq_u32 vcc, -1, v224
    s_nop 0
    s_cmp_lg_u64 vcc, 0
    s_cbranch_scc1 K_RT35
K_RB35:
    s_waitcnt lgkmcnt(0)
    v_mfma_f32_32x32x16_bf16 v[48:63], v[112:115], v[208:211], v[48:63]
    v_mfma_f32_32x32x16_bf16 v[48:63], v[120:123], v[216:219], v[48:63]
    v_mfma_f32_32x32x16_bf16 v[64:79], v[112:115], v[212:215], v[64:79]
    v_mfma_f32_32x32x16_bf16 v[64:79], v[120:123], v[220:223], v[64:79]
    s_barrier
    s_nop 8
    ds_write_b128 v24, v[48:51] offset:0
    ds_write_b128 v24, v[52:55] offset:32
    ds_write_b128 v24, v[56:59] offset:64
    ds_write_b128 v24, v[60:63] offset:96
    v_mfma_f32_32x32x16_bf16 v[80:95], v[116:119], v[208:211], v[80:95]
    v_mfma_f32_32x32x16_bf16 v[80:95], v[124:127], v[216:219], v[80:95]
    s_nop 5
    ds_write_b128 v24, v[64:67] offset:8704
    ds_write_b128 v24, v[68:71] offset:8736
    ds_write_b128 v24, v[72:75] offset:8768
    ds_write_b128 v24, v[76:79] offset:8800
    v_mfma_f32_32x32x16_bf16 v[96:111], v[116:119], v[212:215], v[96:111]
    v_mfma_f32_32x32x16_bf16 v[96:111], v[124:127], v[220:223], v[96:111]
    s_nop 5
    ds_write_b128 v24, v[80:83] offset:128
    ds_write_b128 v24, v[84:87] offset:160
    ds_write_b128 v24, v[88:91] offset:192
    ds_write_b128 v24, v[92:95] offset:224
    s_nop 7
    ds_write_b128 v24, v[96:99] offset:8832
    ds_write_b128 v24, v[100:103] offset:8864
    ds_write_b128 v24, v[104:107] offset:8896
    ds_write_b128 v24, v[108:111] offset:8928
    s_waitcnt lgkmcnt(0)
    s_branch K_LAST
K_GFIN:
    s_setprio 0
    v_lshrrev_b32 v6, 3, v1
    v_lshlrev_b32 v6, 10, v6
    v_and_b32 v224, 7, v1
    v_lshl_add_u32 v6, v224, 4, v6
    s_load_dwordx4 s[72:75], s[0:1], 64
    s_lshr_b32 s39, s27, 2
    s_lshl_b32 s40, s28, 1
    s_add_u32 s40, s40, s39
    s_lshr_b32 s39, s32, 2
    s_lshl_b32 s39, s39, 7
    s_lshl_b32 s56, s25, 1
    s_add_u32 s56, s56, s77
    s_lshl_b32 s55, s40, 16
    s_add_u32 s55, s55, s39
    s_lshl_b32 s38, s56, 13
    s_add_u32 s55, s55, s38
    buffer_load_dwordx4 v[32:35], v6, s[8:11], s55 offen
    v_and_b32 v229, 0x70, v2
    s_waitcnt lgkmcnt(0)
    s_mov_b32 s68, s72
    s_mov_b32 s69, s73
    s_mov_b32 s70, 0x400
    s_mov_b32 s71, 0x00020000
    s_mov_b32 s64, s74
    s_mov_b32 s65, s75
    s_mov_b32 s66, 0x200000
    s_mov_b32 s67, 0x00020000
    buffer_load_dwordx4 v[40:43], v229, s[68:71], s39 offen
    s_waitcnt vmcnt(0)
    v_lshlrev_b32 v26, 16, v40
    v_and_b32 v27, s37, v40
    v_lshlrev_b32 v16, 16, v32
    v_and_b32 v17, s37, v32
    v_add_f32 v16, v16, v26
    v_add_f32 v17, v17, v27
    v_lshlrev_b32 v26, 16, v41
    v_and_b32 v27, s37, v41
    v_lshlrev_b32 v18, 16, v33
    v_and_b32 v19, s37, v33
    v_add_f32 v18, v18, v26
    v_add_f32 v19, v19, v27
    v_lshlrev_b32 v26, 16, v42
    v_and_b32 v27, s37, v42
    v_lshlrev_b32 v20, 16, v34
    v_and_b32 v21, s37, v34
    v_add_f32 v20, v20, v26
    v_add_f32 v21, v21, v27
    v_lshlrev_b32 v26, 16, v43
    v_and_b32 v27, s37, v43
    v_lshlrev_b32 v22, 16, v35
    v_and_b32 v23, s37, v35
    v_add_f32 v22, v22, v26
    v_add_f32 v23, v23, v27
    v_lshrrev_b32 v25, 3, v1
    v_mul_u32_u24 v25, 272, v25
    v_and_b32 v26, 7, v1
    v_lshl_add_u32 v25, v26, 5, v25
    s_mul_i32 s40, s56, 2176
    s_add_u32 s40, s40, 0
    v_add_u32 v25, s40, v25
    s_barrier
K_LAST:
    s_barrier
    ds_read_b128 v[48:51], v25 offset:0
    ds_read_b128 v[52:55], v25 offset:16
    ds_read_b128 v[56:59], v25 offset:17408
    ds_read_b128 v[60:63], v25 offset:17424
    ds_read_b128 v[64:67], v25 offset:34816
    ds_read_b128 v[68:71], v25 offset:34832
    ds_read_b128 v[72:75], v25 offset:52224
    ds_read_b128 v[76:79], v25 offset:52240
    s_waitcnt lgkmcnt(6)
    v_pk_add_f32 v[16:17], v[16:17], v[48:49]
    v_pk_add_f32 v[18:19], v[18:19], v[50:51]
    v_pk_add_f32 v[20:21], v[20:21], v[52:53]
    v_pk_add_f32 v[22:23], v[22:23], v[54:55]
    s_waitcnt lgkmcnt(4)
    v_pk_add_f32 v[16:17], v[16:17], v[56:57]
    v_pk_add_f32 v[18:19], v[18:19], v[58:59]
    v_pk_add_f32 v[20:21], v[20:21], v[60:61]
    v_pk_add_f32 v[22:23], v[22:23], v[62:63]
    s_waitcnt lgkmcnt(2)
    v_pk_add_f32 v[16:17], v[16:17], v[64:65]
    v_pk_add_f32 v[18:19], v[18:19], v[66:67]
    v_pk_add_f32 v[20:21], v[20:21], v[68:69]
    v_pk_add_f32 v[22:23], v[22:23], v[70:71]
    s_waitcnt lgkmcnt(0)
    v_pk_add_f32 v[16:17], v[16:17], v[72:73]
    v_pk_add_f32 v[18:19], v[18:19], v[74:75]
    v_pk_add_f32 v[20:21], v[20:21], v[76:77]
    v_pk_add_f32 v[22:23], v[22:23], v[78:79]
    v_cvt_pk_bf16_f32 v32, v16, v17
    v_cvt_pk_bf16_f32 v33, v18, v19
    v_cvt_pk_bf16_f32 v34, v20, v21
    v_cvt_pk_bf16_f32 v35, v22, v23
    buffer_store_dwordx4 v[32:35], v6, s[64:67], s55 offen
K_FIN:
K_END:
    s_endpgm
K_RT8:
    s_mov_b32 s3, 0
K_RL8:
    s_waitcnt vmcnt(0)
    s_sleep 2
    s_add_u32 s38, s30, 8192
    s_add_u32 s39, s33, 8192
    buffer_load_dwordx4 v[192:195], v238, s[16:19], s38 offen sc1
    buffer_load_dwordx4 v[196:199], v239, s[16:19], s39 offen sc1
    s_add_u32 s38, s30, 10240
    s_add_u32 s39, s33, 10240
    buffer_load_dwordx4 v[200:203], v238, s[16:19], s38 offen sc1
    buffer_load_dwordx4 v[204:207], v239, s[16:19], s39 offen sc1
    s_add_u32 s38, s30, 12288
    s_add_u32 s39, s33, 12288
    buffer_load_dwordx4 v[208:211], v238, s[16:19], s38 offen sc1
    buffer_load_dwordx4 v[212:215], v239, s[16:19], s39 offen sc1
    s_add_u32 s38, s30, 14336
    s_add_u32 s39, s33, 14336
    buffer_load_dwordx4 v[216:219], v238, s[16:19], s38 offen sc1
    buffer_load_dwordx4 v[220:223], v239, s[16:19], s39 offen sc1
    s_add_u32 s38, s30, 40960
    s_add_u32 s39, s33, 40960
    buffer_load_dwordx4 v[128:131], v238, s[16:19], s38 offen sc1
    buffer_load_dwordx4 v[132:135], v239, s[16:19], s39 offen sc1
    s_add_u32 s38, s30, 43008
    s_add_u32 s39, s33, 43008
    buffer_load_dwordx4 v[136:139], v238, s[16:19], s38 offen sc1
    buffer_load_dwordx4 v[140:143], v239, s[16:19], s39 offen sc1
    s_add_u32 s3, s3, 1
    s_waitcnt vmcnt(0)
    s_cmp_ge_u32 s3, 2500
    s_cbranch_scc1 K_RB8
    v_max3_u32 v224, v192, v193, v194
    v_max3_u32 v225, v195, v196, v197
    v_max3_u32 v224, v224, v198, v199
    v_max_u32 v224, v224, v225
    v_cmp_eq_u32 vcc, -1, v224
    s_nop 0
    s_cmp_lg_u64 vcc, 0
    s_cbranch_scc1 K_RL8
    s_branch K_RB8
K_RT9:
    s_mov_b32 s3, 0
K_RL9:
    s_waitcnt vmcnt(0)
    s_sleep 2
    s_add_u32 s38, s30, 10240
    s_add_u32 s39, s33, 10240
    buffer_load_dwordx4 v[200:203], v238, s[16:19], s38 offen sc1
    buffer_load_dwordx4 v[204:207], v239, s[16:19], s39 offen sc1
    s_add_u32 s38, s30, 12288
    s_add_u32 s39, s33, 12288
    buffer_load_dwordx4 v[208:211], v238, s[16:19], s38 offen sc1
    buffer_load_dwordx4 v[212:215], v239, s[16:19], s39 offen sc1
    s_add_u32 s38, s30, 14336
    s_add_u32 s39, s33, 14336
    buffer_load_dwordx4 v[216:219], v238, s[16:19], s38 offen sc1
    buffer_load_dwordx4 v[220:223], v239, s[16:19], s39 offen sc1
    s_add_u32 s38, s30, 40960
    s_add_u32 s39, s33, 40960
    buffer_load_dwordx4 v[128:131], v238, s[16:19], s38 offen sc1
    buffer_load_dwordx4 v[132:135], v239, s[16:19], s39 offen sc1
    s_add_u32 s38, s30, 43008
    s_add_u32 s39, s33, 43008
    buffer_load_dwordx4 v[136:139], v238, s[16:19], s38 offen sc1
    buffer_load_dwordx4 v[140:143], v239, s[16:19], s39 offen sc1
    s_add_u32 s38, s30, 45056
    s_add_u32 s39, s33, 45056
    buffer_load_dwordx4 v[144:147], v238, s[16:19], s38 offen sc1
    buffer_load_dwordx4 v[148:151], v239, s[16:19], s39 offen sc1
    s_add_u32 s3, s3, 1
    s_waitcnt vmcnt(0)
    s_cmp_ge_u32 s3, 2500
    s_cbranch_scc1 K_RB9
    v_max3_u32 v224, v200, v201, v202
    v_max3_u32 v225, v203, v204, v205
    v_max3_u32 v224, v224, v206, v207
    v_max_u32 v224, v224, v225
    v_cmp_eq_u32 vcc, -1, v224
    s_nop 0
    s_cmp_lg_u64 vcc, 0
    s_cbranch_scc1 K_RL9
    s_branch K_RB9
K_RT10:
    s_mov_b32 s3, 0
K_RL10:
    s_waitcnt vmcnt(0)
    s_sleep 2
    s_add_u32 s38, s30, 12288
    s_add_u32 s39, s33, 12288
    buffer_load_dwordx4 v[208:211], v238, s[16:19], s38 offen sc1
    buffer_load_dwordx4 v[212:215], v239, s[16:19], s39 offen sc1
    s_add_u32 s38, s30, 14336
    s_add_u32 s39, s33, 14336
    buffer_load_dwordx4 v[216:219], v238, s[16:19], s38 offen sc1
    buffer_load_dwordx4 v[220:223], v239, s[16:19], s39 offen sc1
    s_add_u32 s38, s30, 40960
    s_add_u32 s39, s33, 40960
    buffer_load_dwordx4 v[128:131], v238, s[16:19], s38 offen sc1
    buffer_load_dwordx4 v[132:135], v239, s[16:19], s39 offen sc1
    s_add_u32 s38, s30, 43008
    s_add_u32 s39, s33, 43008
    buffer_load_dwordx4 v[136:139], v238, s[16:19], s38 offen sc1
    buffer_load_dwordx4 v[140:143], v239, s[16:19], s39 offen sc1
    s_add_u32 s38, s30, 45056
    s_add_u32 s39, s33, 45056
    buffer_load_dwordx4 v[144:147], v238, s[16:19], s38 offen sc1
    buffer_load_dwordx4 v[148:151], v239, s[16:19], s39 offen sc1
    s_add_u32 s38, s30, 47104
    s_add_u32 s39, s33, 47104
    buffer_load_dwordx4 v[152:155], v238, s[16:19], s38 offen sc1
    buffer_load_dwordx4 v[156:159], v239, s[16:19], s39 offen sc1
    s_add_u32 s3, s3, 1
    s_waitcnt vmcnt(0)
    s_cmp_ge_u32 s3, 2500
    s_cbranch_scc1 K_RB10
    v_max3_u32 v224, v208, v209, v210
    v_max3_u32 v225, v211, v212, v213
    v_max3_u32 v224, v224, v214, v215
    v_max_u32 v224, v224, v225
    v_cmp_eq_u32 vcc, -1, v224
    s_nop 0
    s_cmp_lg_u64 vcc, 0
    s_cbranch_scc1 K_RL10
    s_branch K_RB10
K_RT11:
    s_mov_b32 s3, 0
K_RL11:
    s_waitcnt vmcnt(0)
    s_sleep 2
    s_add_u32 s38, s30, 14336
    s_add_u32 s39, s33, 14336
    buffer_load_dwordx4 v[216:219], v238, s[16:19], s38 offen sc1
    buffer_load_dwordx4 v[220:223], v239, s[16:19], s39 offen sc1
    s_add_u32 s38, s30, 40960
    s_add_u32 s39, s33, 40960
    buffer_load_dwordx4 v[128:131], v238, s[16:19], s38 offen sc1
    buffer_load_dwordx4 v[132:135], v239, s[16:19], s39 offen sc1
    s_add_u32 s38, s30, 43008
    s_add_u32 s39, s33, 43008
    buffer_load_dwordx4 v[136:139], v238, s[16:19], s38 offen sc1
    buffer_load_dwordx4 v[140:143], v239, s[16:19], s39 offen sc1
    s_add_u32 s38, s30, 45056
    s_add_u32 s39, s33, 45056
    buffer_load_dwordx4 v[144:147], v238, s[16:19], s38 offen sc1
    buffer_load_dwordx4 v[148:151], v239, s[16:19], s39 offen sc1
    s_add_u32 s38, s30, 47104
    s_add_u32 s39, s33, 47104
    buffer_load_dwordx4 v[152:155], v238, s[16:19], s38 offen sc1
    buffer_load_dwordx4 v[156:159], v239, s[16:19], s39 offen sc1
    s_add_u32 s3, s3, 1
    s_waitcnt vmcnt(0)
    s_cmp_ge_u32 s3, 2500
    s_cbranch_scc1 K_RB11
    v_max3_u32 v224, v216, v217, v218
    v_max3_u32 v225, v219, v220, v221
    v_max3_u32 v224, v224, v222, v223
    v_max_u32 v224, v224, v225
    v_cmp_eq_u32 vcc, -1, v224
    s_nop 0
    s_cmp_lg_u64 vcc, 0
    s_cbranch_scc1 K_RL11
    s_branch K_RB11
K_RT12:
    s_mov_b32 s3, 0
K_RL12:
    s_waitcnt vmcnt(0)
    s_sleep 2
    s_add_u32 s38, s30, 40960
    s_add_u32 s39, s33, 40960
    buffer_load_dwordx4 v[128:131], v238, s[16:19], s38 offen sc1
    buffer_load_dwordx4 v[132:135], v239, s[16:19], s39 offen sc1
    s_add_u32 s38, s30, 43008
    s_add_u32 s39, s33, 43008
    buffer_load_dwordx4 v[136:139], v238, s[16:19], s38 offen sc1
    buffer_load_dwordx4 v[140:143], v239, s[16:19], s39 offen sc1
    s_add_u32 s38, s30, 45056
    s_add_u32 s39, s33, 45056
    buffer_load_dwordx4 v[144:147], v238, s[16:19], s38 offen sc1
    buffer_load_dwordx4 v[148:151], v239, s[16:19], s39 offen sc1
    s_add_u32 s38, s30, 47104
    s_add_u32 s39, s33, 47104
    buffer_load_dwordx4 v[152:155], v238, s[16:19], s38 offen sc1
    buffer_load_dwordx4 v[156:159], v239, s[16:19], s39 offen sc1
    s_add_u32 s3, s3, 1
    s_waitcnt vmcnt(0)
    s_cmp_ge_u32 s3, 2500
    s_cbranch_scc1 K_RB12
    v_max3_u32 v224, v128, v129, v130
    v_max3_u32 v225, v131, v132, v133
    v_max3_u32 v224, v224, v134, v135
    v_max_u32 v224, v224, v225
    v_cmp_eq_u32 vcc, -1, v224
    s_nop 0
    s_cmp_lg_u64 vcc, 0
    s_cbranch_scc1 K_RL12
    s_branch K_RB12
K_RT13:
    s_mov_b32 s3, 0
K_RL13:
    s_waitcnt vmcnt(0)
    s_sleep 2
    s_add_u32 s38, s30, 43008
    s_add_u32 s39, s33, 43008
    buffer_load_dwordx4 v[136:139], v238, s[16:19], s38 offen sc1
    buffer_load_dwordx4 v[140:143], v239, s[16:19], s39 offen sc1
    s_add_u32 s38, s30, 45056
    s_add_u32 s39, s33, 45056
    buffer_load_dwordx4 v[144:147], v238, s[16:19], s38 offen sc1
    buffer_load_dwordx4 v[148:151], v239, s[16:19], s39 offen sc1
    s_add_u32 s38, s30, 47104
    s_add_u32 s39, s33, 47104
    buffer_load_dwordx4 v[152:155], v238, s[16:19], s38 offen sc1
    buffer_load_dwordx4 v[156:159], v239, s[16:19], s39 offen sc1
    s_add_u32 s38, s30, 16384
    s_add_u32 s39, s33, 16384
    buffer_load_dwordx4 v[160:163], v238, s[16:19], s38 offen sc1
    buffer_load_dwordx4 v[164:167], v239, s[16:19], s39 offen sc1
    s_add_u32 s3, s3, 1
    s_waitcnt vmcnt(0)
    s_cmp_ge_u32 s3, 2500
    s_cbranch_scc1 K_RB13
    v_max3_u32 v224, v136, v137, v138
    v_max3_u32 v225, v139, v140, v141
    v_max3_u32 v224, v224, v142, v143
    v_max_u32 v224, v224, v225
    v_cmp_eq_u32 vcc, -1, v224
    s_nop 0
    s_cmp_lg_u64 vcc, 0
    s_cbranch_scc1 K_RL13
    s_branch K_RB13
K_RT14:
    s_mov_b32 s3, 0
K_RL14:
    s_waitcnt vmcnt(0)
    s_sleep 2
    s_add_u32 s38, s30, 45056
    s_add_u32 s39, s33, 45056
    buffer_load_dwordx4 v[144:147], v238, s[16:19], s38 offen sc1
    buffer_load_dwordx4 v[148:151], v239, s[16:19], s39 offen sc1
    s_add_u32 s38, s30, 47104
    s_add_u32 s39, s33, 47104
    buffer_load_dwordx4 v[152:155], v238, s[16:19], s38 offen sc1
    buffer_load_dwordx4 v[156:159], v239, s[16:19], s39 offen sc1
    s_add_u32 s38, s30, 16384
    s_add_u32 s39, s33, 16384
    buffer_load_dwordx4 v[160:163], v238, s[16:19], s38 offen sc1
    buffer_load_dwordx4 v[164:167], v239, s[16:19], s39 offen sc1
    s_add_u32 s38, s30, 18432
    s_add_u32 s39, s33, 18432
    buffer_load_dwordx4 v[168:171], v238, s[16:19], s38 offen sc1
    buffer_load_dwordx4 v[172:175], v239, s[16:19], s39 offen sc1
    s_add_u32 s3, s3, 1
    s_waitcnt vmcnt(0)
    s_cmp_ge_u32 s3, 2500
    s_cbranch_scc1 K_RB14
    v_max3_u32 v224, v144, v145, v146
    v_max3_u32 v225, v147, v148, v149
    v_max3_u32 v224, v224, v150, v151
    v_max_u32 v224, v224, v225
    v_cmp_eq_u32 vcc, -1, v224
    s_nop 0
    s_cmp_lg_u64 vcc, 0
    s_cbranch_scc1 K_RL14
    s_branch K_RB14
K_RT15:
    s_mov_b32 s3, 0
K_RL15:
    s_waitcnt vmcnt(0)
    s_sleep 2
    s_add_u32 s38, s30, 47104
    s_add_u32 s39, s33, 47104
    buffer_load_dwordx4 v[152:155], v238, s[16:19], s38 offen sc1
    buffer_load_dwordx4 v[156:159], v239, s[16:19], s39 offen sc1
    s_add_u32 s38, s30, 16384
    s_add_u32 s39, s33, 16384
    buffer_load_dwordx4 v[160:163], v238, s[16:19], s38 offen sc1
    buffer_load_dwordx4 v[164:167], v239, s[16:19], s39 offen sc1
    s_add_u32 s38, s30, 18432
    s_add_u32 s39, s33, 18432
    buffer_load_dwordx4 v[168:171], v238, s[16:19], s38 offen sc1
    buffer_load_dwordx4 v[172:175], v239, s[16:19], s39 offen sc1
    s_add_u32 s38, s30, 20480
    s_add_u32 s39, s33, 20480
    buffer_load_dwordx4 v[176:179], v238, s[16:19], s38 offen sc1
    buffer_load_dwordx4 v[180:183], v239, s[16:19], s39 offen sc1
    s_add_u32 s3, s3, 1
    s_waitcnt vmcnt(0)
    s_cmp_ge_u32 s3, 2500
    s_cbranch_scc1 K_RB15
    v_max3_u32 v224, v152, v153, v154
    v_max3_u32 v225, v155, v156, v157
    v_max3_u32 v224, v224, v158, v159
    v_max_u32 v224, v224, v225
    v_cmp_eq_u32 vcc, -1, v224
    s_nop 0
    s_cmp_lg_u64 vcc, 0
    s_cbranch_scc1 K_RL15
    s_branch K_RB15
K_RT16:
    s_mov_b32 s3, 0
K_RL16:
    s_waitcnt vmcnt(0)
    s_sleep 2
    s_add_u32 s38, s30, 16384
    s_add_u32 s39, s33, 16384
    buffer_load_dwordx4 v[160:163], v238, s[16:19], s38 offen sc1
    buffer_load_dwordx4 v[164:167], v239, s[16:19], s39 offen sc1
    s_add_u32 s38, s30, 18432
    s_add_u32 s39, s33, 18432
    buffer_load_dwordx4 v[168:171], v238, s[16:19], s38 offen sc1
    buffer_load_dwordx4 v[172:175], v239, s[16:19], s39 offen sc1
    s_add_u32 s38, s30, 20480
    s_add_u32 s39, s33, 20480
    buffer_load_dwordx4 v[176:179], v238, s[16:19], s38 offen sc1
    buffer_load_dwordx4 v[180:183], v239, s[16:19], s39 offen sc1
    s_add_u32 s38, s30, 22528
    s_add_u32 s39, s33, 22528
    buffer_load_dwordx4 v[184:187], v238, s[16:19], s38 offen sc1
    buffer_load_dwordx4 v[188:191], v239, s[16:19], s39 offen sc1
    s_add_u32 s3, s3, 1
    s_waitcnt vmcnt(0)
    s_cmp_ge_u32 s3, 2500
    s_cbranch_scc1 K_RB16
    v_max3_u32 v224, v160, v161, v162
    v_max3_u32 v225, v163, v164, v165
    v_max3_u32 v224, v224, v166, v167
    v_max_u32 v224, v224, v225
    v_cmp_eq_u32 vcc, -1, v224
    s_nop 0
    s_cmp_lg_u64 vcc, 0
    s_cbranch_scc1 K_RL16
    s_branch K_RB16
K_RT17:
    s_mov_b32 s3, 0
K_RL17:
    s_waitcnt vmcnt(0)
    s_sleep 2
    s_add_u32 s38, s30, 18432
    s_add_u32 s39, s33, 18432
    buffer_load_dwordx4 v[168:171], v238, s[16:19], s38 offen sc1
    buffer_load_dwordx4 v[172:175], v239, s[16:19], s39 offen sc1
    s_add_u32 s38, s30, 20480
    s_add_u32 s39, s33, 20480
    buffer_load_dwordx4 v[176:179], v238, s[16:19], s38 offen sc1
    buffer_load_dwordx4 v[180:183], v239, s[16:19], s39 offen sc1
    s_add_u32 s38, s30, 22528
    s_add_u32 s39, s33, 22528
    buffer_load_dwordx4 v[184:187], v238, s[16:19], s38 offen sc1
    buffer_load_dwordx4 v[188:191], v239, s[16:19], s39 offen sc1
    s_add_u32 s38, s30, 49152
    s_add_u32 s39, s33, 49152
    buffer_load_dwordx4 v[192:195], v238, s[16:19], s38 offen sc1
    buffer_load_dwordx4 v[196:199], v239, s[16:19], s39 offen sc1
    s_add_u32 s3, s3, 1
    s_waitcnt vmcnt(0)
    s_cmp_ge_u32 s3, 2500
    s_cbranch_scc1 K_RB17
    v_max3_u32 v224, v168, v169, v170
    v_max3_u32 v225, v171, v172, v173
    v_max3_u32 v224, v224, v174, v175
    v_max_u32 v224, v224, v225
    v_cmp_eq_u32 vcc, -1, v224
    s_nop 0
    s_cmp_lg_u64 vcc, 0
    s_cbranch_scc1 K_RL17
    s_branch K_RB17
K_RT18:
    s_mov_b32 s3, 0
K_RL18:
    s_waitcnt vmcnt(0)
    s_sleep 2
    s_add_u32 s38, s30, 20480
    s_add_u32 s39, s33, 20480
    buffer_load_dwordx4 v[176:179], v238, s[16:19], s38 offen sc1
    buffer_load_dwordx4 v[180:183], v239, s[16:19], s39 offen sc1
    s_add_u32 s38, s30, 22528
    s_add_u32 s39, s33, 22528
    buffer_load_dwordx4 v[184:187], v238, s[16:19], s38 offen sc1
    buffer_load_dwordx4 v[188:191], v239, s[16:19], s39 offen sc1
    s_add_u32 s38, s30, 49152
    s_add_u32 s39, s33, 49152
    buffer_load_dwordx4 v[192:195], v238, s[16:19], s38 offen sc1
    buffer_load_dwordx4 v[196:199], v239, s[16:19], s39 offen sc1
    s_add_u32 s38, s30, 51200
    s_add_u32 s39, s33, 51200
    buffer_load_dwordx4 v[200:203], v238, s[16:19], s38 offen sc1
    buffer_load_dwordx4 v[204:207], v239, s[16:19], s39 offen sc1
    s_add_u32 s3, s3, 1
    s_waitcnt vmcnt(0)
    s_cmp_ge_u32 s3, 2500
    s_cbranch_scc1 K_RB18
    v_max3_u32 v224, v176, v177, v178
    v_max3_u32 v225, v179, v180, v181
    v_max3_u32 v224, v224, v182, v183
    v_max_u32 v224, v224, v225
    v_cmp_eq_u32 vcc, -1, v224
    s_nop 0
    s_cmp_lg_u64 vcc, 0
    s_cbranch_scc1 K_RL18
    s_branch K_RB18
K_RT19:
    s_mov_b32 s3, 0
K_RL19:
    s_waitcnt vmcnt(0)
    s_sleep 2
    s_add_u32 s38, s30, 22528
    s_add_u32 s39, s33, 22528
    buffer_load_dwordx4 v[184:187], v238, s[16:19], s38 offen sc1
    buffer_load_dwordx4 v[188:191], v239, s[16:19], s39 offen sc1
    s_add_u32 s38, s30, 49152
    s_add_u32 s39, s33, 49152
    buffer_load_dwordx4 v[192:195], v238, s[16:19], s38 offen sc1
    buffer_load_dwordx4 v[196:199], v239, s[16:19], s39 offen sc1
    s_add_u32 s38, s30, 51200
    s_add_u32 s39, s33, 51200
    buffer_load_dwordx4 v[200:203], v238, s[16:19], s38 offen sc1
    buffer_load_dwordx4 v[204:207], v239, s[16:19], s39 offen sc1
    s_add_u32 s38, s30, 53248
    s_add_u32 s39, s33, 53248
    buffer_load_dwordx4 v[208:211], v238, s[16:19], s38 offen sc1
    buffer_load_dwordx4 v[212:215], v239, s[16:19], s39 offen sc1
    s_add_u32 s3, s3, 1
    s_waitcnt vmcnt(0)
    s_cmp_ge_u32 s3, 2500
    s_cbranch_scc1 K_RB19
    v_max3_u32 v224, v184, v185, v186
    v_max3_u32 v225, v187, v188, v189
    v_max3_u32 v224, v224, v190, v191
    v_max_u32 v224, v224, v225
    v_cmp_eq_u32 vcc, -1, v224
    s_nop 0
    s_cmp_lg_u64 vcc, 0
    s_cbranch_scc1 K_RL19
    s_branch K_RB19
K_RT20:
    s_mov_b32 s3, 0
K_RL20:
    s_waitcnt vmcnt(0)
    s_sleep 2
    s_add_u32 s38, s30, 49152
    s_add_u32 s39, s33, 49152
    buffer_load_dwordx4 v[192:195], v238, s[16:19], s38 offen sc1
    buffer_load_dwordx4 v[196:199], v239, s[16:19], s39 offen sc1
    s_add_u32 s38, s30, 51200
    s_add_u32 s39, s33, 51200
    buffer_load_dwordx4 v[200:203], v238, s[16:19], s38 offen sc1
    buffer_load_dwordx4 v[204:207], v239, s[16:19], s39 offen sc1
    s_add_u32 s38, s30, 53248
    s_add_u32 s39, s33, 53248
    buffer_load_dwordx4 v[208:211], v238, s[16:19], s38 offen sc1
    buffer_load_dwordx4 v[212:215], v239, s[16:19], s39 offen sc1
    s_add_u32 s38, s30, 55296
    s_add_u32 s39, s33, 55296
    buffer_load_dwordx4 v[216:219], v238, s[16:19], s38 offen sc1
    buffer_load_dwordx4 v[220:223], v239, s[16:19], s39 offen sc1
    s_add_u32 s3, s3, 1
    s_waitcnt vmcnt(0)
    s_cmp_ge_u32 s3, 2500
    s_cbranch_scc1 K_RB20
    v_max3_u32 v224, v192, v193, v194
    v_max3_u32 v225, v195, v196, v197
    v_max3_u32 v224, v224, v198, v199
    v_max_u32 v224, v224, v225
    v_cmp_eq_u32 vcc, -1, v224
    s_nop 0
    s_cmp_lg_u64 vcc, 0
    s_cbranch_scc1 K_RL20
    s_branch K_RB20
K_RT21:
    s_mov_b32 s3, 0
K_RL21:
    s_waitcnt vmcnt(0)
    s_sleep 2
    s_add_u32 s38, s30, 51200
    s_add_u32 s39, s33, 51200
    buffer_load_dwordx4 v[200:203], v238, s[16:19], s38 offen sc1
    buffer_load_dwordx4 v[204:207], v239, s[16:19], s39 offen sc1
    s_add_u32 s38, s30, 53248
    s_add_u32 s39, s33, 53248
    buffer_load_dwordx4 v[208:211], v238, s[16:19], s38 offen sc1
    buffer_load_dwordx4 v[212:215], v239, s[16:19], s39 offen sc1
    s_add_u32 s38, s30, 55296
    s_add_u32 s39, s33, 55296
    buffer_load_dwordx4 v[216:219], v238, s[16:19], s38 offen sc1
    buffer_load_dwordx4 v[220:223], v239, s[16:19], s39 offen sc1
    s_add_u32 s38, s30, 24576
    s_add_u32 s39, s33, 24576
    buffer_load_dwordx4 v[128:131], v238, s[16:19], s38 offen sc1
    buffer_load_dwordx4 v[132:135], v239, s[16:19], s39 offen sc1
    s_add_u32 s3, s3, 1
    s_waitcnt vmcnt(0)
    s_cmp_ge_u32 s3, 2500
    s_cbranch_scc1 K_RB21
    v_max3_u32 v224, v200, v201, v202
    v_max3_u32 v225, v203, v204, v205
    v_max3_u32 v224, v224, v206, v207
    v_max_u32 v224, v224, v225
    v_cmp_eq_u32 vcc, -1, v224
    s_nop 0
    s_cmp_lg_u64 vcc, 0
    s_cbranch_scc1 K_RL21
    s_branch K_RB21
K_RT22:
    s_mov_b32 s3, 0
K_RL22:
    s_waitcnt vmcnt(0)
    s_sleep 2
    s_add_u32 s38, s30, 53248
    s_add_u32 s39, s33, 53248
    buffer_load_dwordx4 v[208:211], v238, s[16:19], s38 offen sc1
    buffer_load_dwordx4 v[212:215], v239, s[16:19], s39 offen sc1
    s_add_u32 s38, s30, 55296
    s_add_u32 s39, s33, 55296
    buffer_load_dwordx4 v[216:219], v238, s[16:19], s38 offen sc1
    buffer_load_dwordx4 v[220:223], v239, s[16:19], s39 offen sc1
    s_add_u32 s38, s30, 24576
    s_add_u32 s39, s33, 24576
    buffer_load_dwordx4 v[128:131], v238, s[16:19], s38 offen sc1
    buffer_load_dwordx4 v[132:135], v239, s[16:19], s39 offen sc1
    s_add_u32 s38, s30, 26624
    s_add_u32 s39, s33, 26624
    buffer_load_dwordx4 v[136:139], v238, s[16:19], s38 offen sc1
    buffer_load_dwordx4 v[140:143], v239, s[16:19], s39 offen sc1
    s_add_u32 s3, s3, 1
    s_waitcnt vmcnt(0)
    s_cmp_ge_u32 s3, 2500
    s_cbranch_scc1 K_RB22
    v_max3_u32 v224, v208, v209, v210
    v_max3_u32 v225, v211, v212, v213
    v_max3_u32 v224, v224, v214, v215
    v_max_u32 v224, v224, v225
    v_cmp_eq_u32 vcc, -1, v224
    s_nop 0
    s_cmp_lg_u64 vcc, 0
    s_cbranch_scc1 K_RL22
    s_branch K_RB22
K_RT23:
    s_mov_b32 s3, 0
K_RL23:
    s_waitcnt vmcnt(0)
    s_sleep 2
    s_add_u32 s38, s30, 55296
    s_add_u32 s39, s33, 55296
    buffer_load_dwordx4 v[216:219], v238, s[16:19], s38 offen sc1
    buffer_load_dwordx4 v[220:223], v239, s[16:19], s39 offen sc1
    s_add_u32 s38, s30, 24576
    s_add_u32 s39, s33, 24576
    buffer_load_dwordx4 v[128:131], v238, s[16:19], s38 offen sc1
    buffer_load_dwordx4 v[132:135], v239, s[16:19], s39 offen sc1
    s_add_u32 s38, s30, 26624
    s_add_u32 s39, s33, 26624
    buffer_load_dwordx4 v[136:139], v238, s[16:19], s38 offen sc1
    buffer_load_dwordx4 v[140:143], v239, s[16:19], s39 offen sc1
    s_add_u32 s38, s30, 28672
    s_add_u32 s39, s33, 28672
    buffer_load_dwordx4 v[144:147], v238, s[16:19], s38 offen sc1
    buffer_load_dwordx4 v[148:151], v239, s[16:19], s39 offen sc1
    s_add_u32 s3, s3, 1
    s_waitcnt vmcnt(0)
    s_cmp_ge_u32 s3, 2500
    s_cbranch_scc1 K_RB23
    v_max3_u32 v224, v216, v217, v218
    v_max3_u32 v225, v219, v220, v221
    v_max3_u32 v224, v224, v222, v223
    v_max_u32 v224, v224, v225
    v_cmp_eq_u32 vcc, -1, v224
    s_nop 0
    s_cmp_lg_u64 vcc, 0
    s_cbranch_scc1 K_RL23
    s_branch K_RB23
K_RT24:
    s_mov_b32 s3, 0
K_RL24:
    s_waitcnt vmcnt(0)
    s_sleep 2
    s_add_u32 s38, s30, 24576
    s_add_u32 s39, s33, 24576
    buffer_load_dwordx4 v[128:131], v238, s[16:19], s38 offen sc1
    buffer_load_dwordx4 v[132:135], v239, s[16:19], s39 offen sc1
    s_add_u32 s38, s30, 26624
    s_add_u32 s39, s33, 26624
    buffer_load_dwordx4 v[136:139], v238, s[16:19], s38 offen sc1
    buffer_load_dwordx4 v[140:143], v239, s[16:19], s39 offen sc1
    s_add_u32 s38, s30, 28672
    s_add_u32 s39, s33, 28672
    buffer_load_dwordx4 v[144:147], v238, s[16:19], s38 offen sc1
    buffer_load_dwordx4 v[148:151], v239, s[16:19], s39 offen sc1
    s_add_u32 s38, s30, 30720
    s_add_u32 s39, s33, 30720
    buffer_load_dwordx4 v[152:155], v238, s[16:19], s38 offen sc1
    buffer_load_dwordx4 v[156:159], v239, s[16:19], s39 offen sc1
    s_add_u32 s3, s3, 1
    s_waitcnt vmcnt(0)
    s_cmp_ge_u32 s3, 2500
    s_cbranch_scc1 K_RB24
    v_max3_u32 v224, v128, v129, v130
    v_max3_u32 v225, v131, v132, v133
    v_max3_u32 v224, v224, v134, v135
    v_max_u32 v224, v224, v225
    v_cmp_eq_u32 vcc, -1, v224
    s_nop 0
    s_cmp_lg_u64 vcc, 0
    s_cbranch_scc1 K_RL24
    s_branch K_RB24
K_RT25:
    s_mov_b32 s3, 0
K_RL25:
    s_waitcnt vmcnt(0)
    s_sleep 2
    s_add_u32 s38, s30, 26624
    s_add_u32 s39, s33, 26624
    buffer_load_dwordx4 v[136:139], v238, s[16:19], s38 offen sc1
    buffer_load_dwordx4 v[140:143], v239, s[16:19], s39 offen sc1
    s_add_u32 s38, s30, 28672
    s_add_u32 s39, s33, 28672
    buffer_load_dwordx4 v[144:147], v238, s[16:19], s38 offen sc1
    buffer_load_dwordx4 v[148:151], v239, s[16:19], s39 offen sc1
    s_add_u32 s38, s30, 30720
    s_add_u32 s39, s33, 30720
    buffer_load_dwordx4 v[152:155], v238, s[16:19], s38 offen sc1
    buffer_load_dwordx4 v[156:159], v239, s[16:19], s39 offen sc1
    s_add_u32 s38, s51, 0
    s_add_u32 s39, s53, 0
    buffer_load_dwordx4 v[160:163], v238, s[16:19], s38 offen sc1
    buffer_load_dwordx4 v[164:167], v239, s[16:19], s39 offen sc1
    s_add_u32 s3, s3, 1
    s_waitcnt vmcnt(0)
    s_cmp_ge_u32 s3, 2500
    s_cbranch_scc1 K_RB25
    v_max3_u32 v224, v136, v137, v138
    v_max3_u32 v225, v139, v140, v141
    v_max3_u32 v224, v224, v142, v143
    v_max_u32 v224, v224, v225
    v_cmp_eq_u32 vcc, -1, v224
    s_nop 0
    s_cmp_lg_u64 vcc, 0
    s_cbranch_scc1 K_RL25
    s_branch K_RB25
K_RT26:
    s_mov_b32 s3, 0
K_RL26:
    s_waitcnt vmcnt(0)
    s_sleep 2
    s_add_u32 s38, s30, 28672
    s_add_u32 s39, s33, 28672
    buffer_load_dwordx4 v[144:147], v238, s[16:19], s38 offen sc1
    buffer_load_dwordx4 v[148:151], v239, s[16:19], s39 offen sc1
    s_add_u32 s38, s30, 30720
    s_add_u32 s39, s33, 30720
    buffer_load_dwordx4 v[152:155], v238, s[16:19], s38 offen sc1
    buffer_load_dwordx4 v[156:159], v239, s[16:19], s39 offen sc1
    s_add_u32 s38, s51, 0
    s_add_u32 s39, s53, 0
    buffer_load_dwordx4 v[160:163], v238, s[16:19], s38 offen sc1
    buffer_load_dwordx4 v[164:167], v239, s[16:19], s39 offen sc1
    s_add_u32 s38, s51, 2048
    s_add_u32 s39, s53, 2048
    buffer_load_dwordx4 v[168:171], v238, s[16:19], s38 offen sc1
    buffer_load_dwordx4 v[172:175], v239, s[16:19], s39 offen sc1
    s_add_u32 s3, s3, 1
    s_waitcnt vmcnt(0)
    s_cmp_ge_u32 s3, 2500
    s_cbranch_scc1 K_RB26
    v_max3_u32 v224, v144, v145, v146
    v_max3_u32 v225, v147, v148, v149
    v_max3_u32 v224, v224, v150, v151
    v_max_u32 v224, v224, v225
    v_cmp_eq_u32 vcc, -1, v224
    s_nop 0
    s_cmp_lg_u64 vcc, 0
    s_cbranch_scc1 K_RL26
    s_branch K_RB26
K_RT27:
    s_mov_b32 s3, 0
K_RL27:
    s_waitcnt vmcnt(0)
    s_sleep 2
    s_add_u32 s38, s30, 30720
    s_add_u32 s39, s33, 30720
    buffer_load_dwordx4 v[152:155], v238, s[16:19], s38 offen sc1
    buffer_load_dwordx4 v[156:159], v239, s[16:19], s39 offen sc1
    s_add_u32 s38, s51, 0
    s_add_u32 s39, s53, 0
    buffer_load_dwordx4 v[160:163], v238, s[16:19], s38 offen sc1
    buffer_load_dwordx4 v[164:167], v239, s[16:19], s39 offen sc1
    s_add_u32 s38, s51, 2048
    s_add_u32 s39, s53, 2048
    buffer_load_dwordx4 v[168:171], v238, s[16:19], s38 offen sc1
    buffer_load_dwordx4 v[172:175], v239, s[16:19], s39 offen sc1
    s_add_u32 s38, s51, 4096
    s_add_u32 s39, s53, 4096
    buffer_load_dwordx4 v[176:179], v238, s[16:19], s38 offen sc1
    buffer_load_dwordx4 v[180:183], v239, s[16:19], s39 offen sc1
    s_add_u32 s3, s3, 1
    s_waitcnt vmcnt(0)
    s_cmp_ge_u32 s3, 2500
    s_cbranch_scc1 K_RB27
    v_max3_u32 v224, v152, v153, v154
    v_max3_u32 v225, v155, v156, v157
    v_max3_u32 v224, v224, v158, v159
    v_max_u32 v224, v224, v225
    v_cmp_eq_u32 vcc, -1, v224
    s_nop 0
    s_cmp_lg_u64 vcc, 0
    s_cbranch_scc1 K_RL27
    s_branch K_RB27
K_RT28:
    s_mov_b32 s3, 0
K_RL28:
    s_waitcnt vmcnt(0)
    s_sleep 2
    s_add_u32 s38, s51, 0
    s_add_u32 s39, s53, 0
    buffer_load_dwordx4 v[160:163], v238, s[16:19], s38 offen sc1
    buffer_load_dwordx4 v[164:167], v239, s[16:19], s39 offen sc1
    s_add_u32 s38, s51, 2048
    s_add_u32 s39, s53, 2048
    buffer_load_dwordx4 v[168:171], v238, s[16:19], s38 offen sc1
    buffer_load_dwordx4 v[172:175], v239, s[16:19], s39 offen sc1
    s_add_u32 s38, s51, 4096
    s_add_u32 s39, s53, 4096
    buffer_load_dwordx4 v[176:179], v238, s[16:19], s38 offen sc1
    buffer_load_dwordx4 v[180:183], v239, s[16:19], s39 offen sc1
    s_add_u32 s38, s51, 6144
    s_add_u32 s39, s53, 6144
    buffer_load_dwordx4 v[184:187], v238, s[16:19], s38 offen sc1
    buffer_load_dwordx4 v[188:191], v239, s[16:19], s39 offen sc1
    s_add_u32 s3, s3, 1
    s_waitcnt vmcnt(0)
    s_cmp_ge_u32 s3, 2500
    s_cbranch_scc1 K_RB28
    v_max3_u32 v224, v160, v161, v162
    v_max3_u32 v225, v163, v164, v165
    v_max3_u32 v224, v224, v166, v167
    v_max_u32 v224, v224, v225
    v_cmp_eq_u32 vcc, -1, v224
    s_nop 0
    s_cmp_lg_u64 vcc, 0
    s_cbranch_scc1 K_RL28
    s_branch K_RB28
K_RT29:
    s_mov_b32 s3, 0
K_RL29:
    s_waitcnt vmcnt(0)
    s_sleep 2
    s_add_u32 s38, s51, 2048
    s_add_u32 s39, s53, 2048
    buffer_load_dwordx4 v[168:171], v238, s[16:19], s38 offen sc1
    buffer_load_dwordx4 v[172:175], v239, s[16:19], s39 offen sc1
    s_add_u32 s38, s51, 4096
    s_add_u32 s39, s53, 4096
    buffer_load_dwordx4 v[176:179], v238, s[16:19], s38 offen sc1
    buffer_load_dwordx4 v[180:183], v239, s[16:19], s39 offen sc1
    s_add_u32 s38, s51, 6144
    s_add_u32 s39, s53, 6144
    buffer_load_dwordx4 v[184:187], v238, s[16:19], s38 offen sc1
    buffer_load_dwordx4 v[188:191], v239, s[16:19], s39 offen sc1
    s_add_u32 s38, s51, 8192
    s_add_u32 s39, s53, 8192
    buffer_load_dwordx4 v[192:195], v238, s[16:19], s38 offen sc1
    buffer_load_dwordx4 v[196:199], v239, s[16:19], s39 offen sc1
    s_add_u32 s3, s3, 1
    s_waitcnt vmcnt(0)
    s_cmp_ge_u32 s3, 2500
    s_cbranch_scc1 K_RB29
    v_max3_u32 v224, v168, v169, v170
    v_max3_u32 v225, v171, v172, v173
    v_max3_u32 v224, v224, v174, v175
    v_max_u32 v224, v224, v225
    v_cmp_eq_u32 vcc, -1, v224
    s_nop 0
    s_cmp_lg_u64 vcc, 0
    s_cbranch_scc1 K_RL29
    s_branch K_RB29
K_RT30:
    s_mov_b32 s3, 0
K_RL30:
    s_waitcnt vmcnt(0)
    s_sleep 2
    s_add_u32 s38, s51, 4096
    s_add_u32 s39, s53, 4096
    buffer_load_dwordx4 v[176:179], v238, s[16:19], s38 offen sc1
    buffer_load_dwordx4 v[180:183], v239, s[16:19], s39 offen sc1
    s_add_u32 s38, s51, 6144
    s_add_u32 s39, s53, 6144
    buffer_load_dwordx4 v[184:187], v238, s[16:19], s38 offen sc1
    buffer_load_dwordx4 v[188:191], v239, s[16:19], s39 offen sc1
    s_add_u32 s38, s51, 8192
    s_add_u32 s39, s53, 8192
    buffer_load_dwordx4 v[192:195], v238, s[16:19], s38 offen sc1
    buffer_load_dwordx4 v[196:199], v239, s[16:19], s39 offen sc1
    s_add_u32 s38, s51, 10240
    s_add_u32 s39, s53, 10240
    buffer_load_dwordx4 v[200:203], v238, s[16:19], s38 offen sc1
    buffer_load_dwordx4 v[204:207], v239, s[16:19], s39 offen sc1
    s_add_u32 s3, s3, 1
    s_waitcnt vmcnt(0)
    s_cmp_ge_u32 s3, 2500
    s_cbranch_scc1 K_RB30
    v_max3_u32 v224, v176, v177, v178
    v_max3_u32 v225, v179, v180, v181
    v_max3_u32 v224, v224, v182, v183
    v_max_u32 v224, v224, v225
    v_cmp_eq_u32 vcc, -1, v224
    s_nop 0
    s_cmp_lg_u64 vcc, 0
    s_cbranch_scc1 K_RL30
    s_branch K_RB30
K_RT31:
    s_mov_b32 s3, 0
K_RL31:
    s_waitcnt vmcnt(0)
    s_sleep 2
    s_add_u32 s38, s51, 6144
    s_add_u32 s39, s53, 6144
    buffer_load_dwordx4 v[184:187], v238, s[16:19], s38 offen sc1
    buffer_load_dwordx4 v[188:191], v239, s[16:19], s39 offen sc1
    s_add_u32 s38, s51, 8192
    s_add_u32 s39, s53, 8192
    buffer_load_dwordx4 v[192:195], v238, s[16:19], s38 offen sc1
    buffer_load_dwordx4 v[196:199], v239, s[16:19], s39 offen sc1
    s_add_u32 s38, s51, 10240
    s_add_u32 s39, s53, 10240
    buffer_load_dwordx4 v[200:203], v238, s[16:19], s38 offen sc1
    buffer_load_dwordx4 v[204:207], v239, s[16:19], s39 offen sc1
    s_add_u32 s38, s51, 12288
    s_add_u32 s39, s53, 12288
    buffer_load_dwordx4 v[208:211], v238, s[16:19], s38 offen sc1
    buffer_load_dwordx4 v[212:215], v239, s[16:19], s39 offen sc1
    s_add_u32 s3, s3, 1
    s_waitcnt vmcnt(0)
    s_cmp_ge_u32 s3, 2500
    s_cbranch_scc1 K_RB31
    v_max3_u32 v224, v184, v185, v186
    v_max3_u32 v225, v187, v188, v189
    v_max3_u32 v224, v224, v190, v191
    v_max_u32 v224, v224, v225
    v_cmp_eq_u32 vcc, -1, v224
    s_nop 0
    s_cmp_lg_u64 vcc, 0
    s_cbranch_scc1 K_RL31
    s_branch K_RB31
K_RT32:
    s_mov_b32 s3, 0
K_RL32:
    s_waitcnt vmcnt(0)
    s_sleep 2
    s_add_u32 s38, s51, 8192
    s_add_u32 s39, s53, 8192
    buffer_load_dwordx4 v[192:195], v238, s[16:19], s38 offen sc1
    buffer_load_dwordx4 v[196:199], v239, s[16:19], s39 offen sc1
    s_add_u32 s38, s51, 10240
    s_add_u32 s39, s53, 10240
    buffer_load_dwordx4 v[200:203], v238, s[16:19], s38 offen sc1
    buffer_load_dwordx4 v[204:207], v239, s[16:19], s39 offen sc1
    s_add_u32 s38, s51, 12288
    s_add_u32 s39, s53, 12288
    buffer_load_dwordx4 v[208:211], v238, s[16:19], s38 offen sc1
    buffer_load_dwordx4 v[212:215], v239, s[16:19], s39 offen sc1
    s_add_u32 s38, s51, 14336
    s_add_u32 s39, s53, 14336
    buffer_load_dwordx4 v[216:219], v238, s[16:19], s38 offen sc1
    buffer_load_dwordx4 v[220:223], v239, s[16:19], s39 offen sc1
    s_add_u32 s3, s3, 1
    s_waitcnt vmcnt(0)
    s_cmp_ge_u32 s3, 2500
    s_cbranch_scc1 K_RB32
    v_max3_u32 v224, v192, v193, v194
    v_max3_u32 v225, v195, v196, v197
    v_max3_u32 v224, v224, v198, v199
    v_max_u32 v224, v224, v225
    v_cmp_eq_u32 vcc, -1, v224
    s_nop 0
    s_cmp_lg_u64 vcc, 0
    s_cbranch_scc1 K_RL32
    s_branch K_RB32
K_RT33:
    s_mov_b32 s3, 0
K_RL33:
    s_waitcnt vmcnt(0)
    s_sleep 2
    s_add_u32 s38, s51, 10240
    s_add_u32 s39, s53, 10240
    buffer_load_dwordx4 v[200:203], v238, s[16:19], s38 offen sc1
    buffer_load_dwordx4 v[204:207], v239, s[16:19], s39 offen sc1
    s_add_u32 s38, s51, 12288
    s_add_u32 s39, s53, 12288
    buffer_load_dwordx4 v[208:211], v238, s[16:19], s38 offen sc1
    buffer_load_dwordx4 v[212:215], v239, s[16:19], s39 offen sc1
    s_add_u32 s38, s51, 14336
    s_add_u32 s39, s53, 14336
    buffer_load_dwordx4 v[216:219], v238, s[16:19], s38 offen sc1
    buffer_load_dwordx4 v[220:223], v239, s[16:19], s39 offen sc1
    s_add_u32 s3, s3, 1
    s_waitcnt vmcnt(0)
    s_cmp_ge_u32 s3, 2500
    s_cbranch_scc1 K_RB33
    v_max3_u32 v224, v200, v201, v202
    v_max3_u32 v225, v203, v204, v205
    v_max3_u32 v224, v224, v206, v207
    v_max_u32 v224, v224, v225
    v_cmp_eq_u32 vcc, -1, v224
    s_nop 0
    s_cmp_lg_u64 vcc, 0
    s_cbranch_scc1 K_RL33
    s_branch K_RB33
K_RT34:
    s_mov_b32 s3, 0
K_RL34:
    s_waitcnt vmcnt(0)
    s_sleep 2
    s_add_u32 s38, s51, 12288
    s_add_u32 s39, s53, 12288
    buffer_load_dwordx4 v[208:211], v238, s[16:19], s38 offen sc1
    buffer_load_dwordx4 v[212:215], v239, s[16:19], s39 offen sc1
    s_add_u32 s38, s51, 14336
    s_add_u32 s39, s53, 14336
    buffer_load_dwordx4 v[216:219], v238, s[16:19], s38 offen sc1
    buffer_load_dwordx4 v[220:223], v239, s[16:19], s39 offen sc1
    s_add_u32 s3, s3, 1
    s_waitcnt vmcnt(0)
    s_cmp_ge_u32 s3, 2500
    s_cbranch_scc1 K_RB34
    v_max3_u32 v224, v208, v209, v210
    v_max3_u32 v225, v211, v212, v213
    v_max3_u32 v224, v224, v214, v215
    v_max_u32 v224, v224, v225
    v_cmp_eq_u32 vcc, -1, v224
    s_nop 0
    s_cmp_lg_u64 vcc, 0
    s_cbranch_scc1 K_RL34
    s_branch K_RB34
K_RT35:
    s_mov_b32 s3, 0
K_RL35:
    s_waitcnt vmcnt(0)
    s_sleep 2
    s_add_u32 s38, s51, 14336
    s_add_u32 s39, s53, 14336
    buffer_load_dwordx4 v[216:219], v238, s[16:19], s38 offen sc1
    buffer_load_dwordx4 v[220:223], v239, s[16:19], s39 offen sc1
    s_add_u32 s3, s3, 1
    s_waitcnt vmcnt(0)
    s_cmp_ge_u32 s3, 2500
    s_cbranch_scc1 K_RB35
    v_max3_u32 v224, v216, v217, v218
    v_max3_u32 v225, v219, v220, v221
    v_max3_u32 v224, v224, v222, v223
    v_max_u32 v224, v224, v225
    v_cmp_eq_u32 vcc, -1, v224
    s_nop 0
    s_cmp_lg_u64 vcc, 0
    s_cbranch_scc1 K_RL35
    s_branch K_RB35
.p2align 8
.fill 1536, 4, 0xbf800000
.section .rodata,"a"
.p2align 6
.amdhsa_kernel parallel_sum__linear_kernel_hedgehog__dense_activation_gelu__prompt_kernel
  .amdhsa_next_free_vgpr 256
  .amdhsa_next_free_sgpr 102
  .amdhsa_accum_offset 256
  .amdhsa_group_segment_fixed_size 0
  .amdhsa_kernarg_size 96
  .amdhsa_user_sgpr_count 2
  .amdhsa_user_sgpr_kernarg_segment_ptr 1
  .amdhsa_system_sgpr_workgroup_id_x 1
.end_amdhsa_kernel
```
